```python
import torch

def _softmax(x, axis=-1):
    return torch.softmax(x, dim=axis)
def _gelu(x):
    return torch.nn.functional.gelu(x, approximate="tanh")
def _silu(x):
    return torch.nn.functional.silu(x)
def _sigmoid(x):
    return torch.sigmoid(x)
def _layernorm(x, axis=-1, eps=1e-5):
    m = x.mean(dim=axis, keepdim=True)
    v = x.var(dim=axis, keepdim=True, unbiased=False)
    return (x - m) / torch.sqrt(v + eps)
def _scatter_add(tgt, idx, src, axis=0):
    return tgt.clone().index_add_(axis, idx, src)
def _segment_sum(src, seg, n):
    out = torch.zeros((n,) + src.shape[1:], dtype=src.dtype)
    return out.index_add_(0, seg, src)
def _pad(x, pw):
    flat = tuple(v for pair in reversed(pw) for v in pair)
    return torch.nn.functional.pad(x, flat)

kernel_name = 'concat_heads__softmax_full_mha__softmax_full_mha__prompt'

def setup_inputs():

    _w = (lambda a: (lambda t: t.to(torch.bfloat16) if t.is_floating_point() else t)(torch.as_tensor(a)))
    def _A_setup():
        B, S, D = 1, 2048, 512
        return {
            "x": _w((lambda *s: torch.randn(*s, dtype=torch.bfloat16) * 0.2)(B, S, D)),
            "wqkv": _w((lambda *s: torch.randn(*s, dtype=torch.bfloat16) * 0.2)(D, 3 * D)),
            "wo": _w((lambda *s: torch.randn(*s, dtype=torch.bfloat16) * 0.05)(D, D)),
        }
    _A_in = _A_setup()

    def _B_setup():
        B, S, D = 1, 2048, 512
        return {
            "x": _w((lambda *s: torch.randn(*s, dtype=torch.bfloat16) * 0.2)(B, S, D)),
            "wqkv": _w((lambda *s: torch.randn(*s, dtype=torch.bfloat16) * 0.2)(D, 3 * D)),
            "wo": _w((lambda *s: torch.randn(*s, dtype=torch.bfloat16) * 0.05)(D, D)),
        }
    _B_in = _B_setup()

    return {
        "A_x": _A_in["x"],
        "A_wqkv": _A_in["wqkv"],
        "A_wo": _A_in["wo"],
        "B_x": _B_in["x"],
        "B_wqkv": _B_in["wqkv"],
        "B_wo": _B_in["wo"],
    }

def reference(A_x, A_wqkv, A_wo, B_x, B_wqkv, B_wo):
    def _A_ref(x, wqkv, wo):
        B, S, D = x.shape
        H = 32; Dh = D // H
        qkv = (lambda x, *d: x.permute(*d))((x @ wqkv).reshape(B, S, 3, H, Dh), 2, 0, 3, 1, 4)
        q, k, v = qkv[0], qkv[1], qkv[2]
        scale = Dh ** -0.5
        scores = torch.einsum("bhqd,bhkd->bhqk", q, k) * scale
        p = _softmax(scores, axis=-1)
        o = torch.einsum("bhqk,bhkd->bhqd", p, v)
        return (lambda x, *d: x.permute(*d))(o, 0, 2, 1, 3).reshape(B, S, D) @ wo

    def _B_ref(x, wqkv, wo):
        B, S, D = x.shape
        H = 32; Dh = D // H
        qkv = (lambda x, *d: x.permute(*d))((x @ wqkv).reshape(B, S, 3, H, Dh), 2, 0, 3, 1, 4)
        q, k, v = qkv[0], qkv[1], qkv[2]
        scale = Dh ** -0.5
        scores = torch.einsum("bhqd,bhkd->bhqk", q, k) * scale
        p = _softmax(scores, axis=-1)
        o = torch.einsum("bhqk,bhkd->bhqd", p, v)
        return (lambda x, *d: x.permute(*d))(o, 0, 2, 1, 3).reshape(B, S, D) @ wo

    a = _A_ref(A_x, A_wqkv, A_wo)
    b = _B_ref(B_x, B_wqkv, B_wo)
    return torch.concatenate([a, b], axis=-1)
```

```asm
; @launch grid=(256,1,1) block=(512,1,1) lds=163840
.amdgcn_target "amdgcn-amd-amdhsa--gfx950"
.text
.globl concat_heads__softmax_full_mha__softmax_full_mha__prompt_kernel
.p2align 8
.type concat_heads__softmax_full_mha__softmax_full_mha__prompt_kernel,@function
concat_heads__softmax_full_mha__softmax_full_mha__prompt_kernel:
    s_cmp_ge_u32 s2, 256
    s_cbranch_scc1 F_end
    s_load_dwordx16 s[16:31], s[0:1], 0
    s_load_dwordx2 s[32:33], s[0:1], 64
    v_lshrrev_b32 v1, 6, v0
    v_and_b32 v2, 63, v0
    s_and_b32 s7, s2, 7
    v_readfirstlane_b32 s10, v1
    s_lshr_b32 s8, s2, 3
    s_lshr_b32 s4, s7, 2
    s_and_b32 s5, s7, 1
    s_lshl_b32 s5, s5, 3
    s_and_b32 s9, s8, 7
    s_or_b32 s5, s5, s9
    s_bfe_u32 s6, s7, 0x10001
    s_lshl_b32 s6, s6, 2
    s_lshr_b32 s9, s8, 3
    s_or_b32 s6, s6, s9
    v_lshrrev_b32 v3, 3, v2
    v_lshlrev_b32 v3, 10, v3
    v_lshrrev_b32 v8, 4, v2
    v_xor_b32 v8, v2, v8
    v_and_b32 v8, 7, v8
    v_lshl_add_u32 v5, v8, 4, v3
    v_xor_b32 v6, 64, v5
    v_add_u32 v6, 7168, v6
    v_add_u32 v7, 14336, v5
    v_add_u32 v8, 14336, v6
    v_lshrrev_b32 v3, 2, v2
    v_mul_u32_u24 v3, 3072, v3
    v_and_b32 v10, 3, v2
    v_lshl_add_u32 v9, v10, 4, v3
    s_lshl_b32 s52, s6, 18
    s_lshl_b32 s11, s10, 15
    s_add_u32 s52, s52, s11
    s_lshl_b32 s53, s5, 6
    s_mul_i32 s11, s10, 49152
    s_add_u32 s53, s53, s11
    s_lshl_b32 s54, s10, 10
    s_lshl_b32 s55, s10, 13
    s_add_u32 s55, s55, 98304
    s_add_u32 s9, s5, s6
    s_lshl_b32 s9, s9, 1
    s_add_u32 s9, s9, s7
    s_mov_b32 s42, 2097152
    s_mov_b32 s43, 0x00020000
    s_mov_b32 s46, 1572864
    s_mov_b32 s47, 0x00020000
    s_add_u32 s11, s9, 0
    s_and_b32 s11, s11, 3
    s_lshl_b32 s64, s11, 8
    s_add_u32 s64, s64, s52
    s_mul_i32 s60, s11, 393216
    s_add_u32 s60, s60, s53
    s_cmp_eq_u32 s4, 0
    s_waitcnt lgkmcnt(0)
    s_cselect_b32 s44, s18, s24
    s_cselect_b32 s45, s19, s25
    s_cselect_b32 s40, s16, s22
    s_cselect_b32 s41, s17, s23
    s_add_u32 m0, s54, 0
    s_nop 0
    buffer_load_dwordx4 v9, s[44:47], s60 offen offset:0 lds
    s_add_u32 m0, s54, 7168
    s_nop 0
    buffer_load_dwordx4 v9, s[44:47], s60 offen offset:1024 lds
    s_add_u32 m0, s54, 14336
    s_nop 0
    buffer_load_dwordx4 v9, s[44:47], s60 offen offset:2048 lds
    s_add_u32 m0, s55, 0
    s_nop 0
    buffer_load_dwordx4 v5, s[40:43], s64 offen offset:0 lds
    buffer_load_dwordx4 v6, s[40:43], s64 offen offset:1024 lds
    buffer_load_dwordx4 v7, s[40:43], s64 offen offset:2048 lds
    buffer_load_dwordx4 v8, s[40:43], s64 offen offset:3072 lds
    s_barrier
    s_add_u32 m0, s55, 3968
    s_nop 0
    buffer_load_dwordx4 v5, s[40:43], s64 offen offset:128 lds
    buffer_load_dwordx4 v6, s[40:43], s64 offen offset:1152 lds
    buffer_load_dwordx4 v7, s[40:43], s64 offen offset:2176 lds
    buffer_load_dwordx4 v8, s[40:43], s64 offen offset:3200 lds
    s_mov_b32 s48, s32
    s_mov_b32 s49, s33
    s_mov_b32 s50, 16777216
    s_mov_b32 s51, 0x00020000
    s_mov_b32 s36, s30
    s_mov_b32 s37, s31
    s_mov_b32 s38, 256
    s_mov_b32 s39, 0x00020000
    s_add_u32 s11, s9, 1
    s_and_b32 s11, s11, 3
    s_lshl_b32 s65, s11, 8
    s_add_u32 s65, s65, s52
    s_mul_i32 s61, s11, 393216
    s_add_u32 s61, s61, s53
    s_add_u32 s11, s9, 2
    s_and_b32 s11, s11, 3
    s_lshl_b32 s66, s11, 8
    s_add_u32 s66, s66, s52
    s_mul_i32 s62, s11, 393216
    s_add_u32 s62, s62, s53
    s_add_u32 s11, s9, 3
    s_and_b32 s11, s11, 3
    s_lshl_b32 s67, s11, 8
    s_add_u32 s67, s67, s52
    s_mul_i32 s63, s11, 393216
    s_add_u32 s63, s63, s53
    v_lshlrev_b32 v4, 4, v2
    s_lshl_b32 s11, s4, 4
    s_add_u32 s11, s11, s5
    s_lshl_b32 s13, s11, 18
    s_lshl_b32 s59, s11, 3
    s_add_u32 s57, s59, s10
    s_mul_i32 s57, s57, 384
    s_add_u32 s57, s57, 12582912
    v_and_b32 v3, 7, v2
    v_lshlrev_b32 v233, 2, v3
    v_mul_u32_u24 v220, 260, v3
    s_lshl_b32 s3, s4, 3
    s_add_u32 s3, s3, s6
    s_mul_i32 s7, s3, 6144
    s_add_u32 s7, s7, 14680064
    v_and_b32 v3, 15, v2
    v_mul_u32_u24 v236, 384, v3
    v_lshlrev_b32 v239, 3, v3
    buffer_load_dword v232, v233, s[48:51], s57 offen sc1
    buffer_load_dword v235, v236, s[48:51], s7 offen sc1
    v_and_b32 v3, 31, v2
    v_lshrrev_b32 v1, 5, v2
    v_bfe_u32 v13, v3, 1, 3
    v_xor_b32 v13, v13, v1
    v_lshlrev_b32 v13, 4, v13
    v_lshl_add_u32 v10, v3, 7, v13
    v_add_u32 v10, s55, v10
    v_xor_b32 v11, 32, v10
    v_xor_b32 v12, 64, v10
    v_xor_b32 v13, 0x60, v10
    v_lshlrev_b32 v14, 9, v1
    v_bfe_u32 v3, v2, 2, 2
    v_lshl_add_u32 v14, v3, 6, v14
    v_bfe_u32 v3, v2, 4, 1
    v_lshl_add_u32 v14, v3, 5, v14
    v_and_b32 v3, 3, v2
    v_lshl_add_u32 v14, v3, 3, v14
    v_add_u32 v15, 49152, v14
    v_lshrrev_b32 v1, 5, v2
    s_lshl_b32 s12, s10, 12
    s_add_u32 s13, s13, s12
    s_lshl_b32 s58, s6, 15
    s_add_u32 s58, s58, s13
    s_mul_i32 s56, s10, 4128
    s_add_u32 s56, s56, 2048
    v_and_b32 v3, 0x33, v2
    v_bfe_u32 v120, v2, 2, 1
    v_lshl_or_b32 v3, v120, 3, v3
    v_bfe_u32 v120, v2, 3, 1
    v_lshl_or_b32 v3, v120, 2, v3
    v_lshlrev_b32 v228, 4, v3
    v_and_b32 v3, 15, v2
    v_lshlrev_b32 v230, 4, v3
    v_lshl_add_u32 v230, v1, 8, v230
    v_bfe_u32 v120, v2, 4, 1
    v_lshl_add_u32 v229, v120, 11, v230
    v_add_u32 v229, 1024, v229
    v_add_u32 v226, s56, v228
    v_add_u32 v227, s56, v229
    v_add_u32 v225, s55, v4
    v_lshlrev_b32 v219, 2, v2
    v_add_u32 v248, s55, v219
    s_lshr_b32 s34, s10, 2
    s_and_b32 s35, s10, 3
    s_lshl_b32 s8, s34, 11
    s_lshl_b32 s11, s35, 14
    s_add_u32 s11, s11, 103424
    s_lshl_b32 s12, s34, 8
    s_add_u32 s12, s12, s11
    v_add_u32 v247, s12, v219
    s_lshl_b32 s12, s34, 10
    s_add_u32 s11, s11, s12
    v_add_u32 v224, s11, v4
    s_add_u32 s11, s8, 2048
    v_add_u32 v216, s11, v4
    v_add_u32 v217, s11, v230
    v_add_u32 v217, 1024, v217
    v_add_u32 v218, 512, v217
    v_mov_b32 v120, 6144
    v_mov_b32 v121, 6160
    v_and_b32 v3, 0x1b, v2
    v_cmp_eq_u32 vcc, 16, v3
    v_and_b32 v3, 16, v2
    s_lshl_b32 s11, s10, 8
    v_cndmask_b32 v120, v120, v121, vcc
    v_cmp_eq_u32 vcc, 0, v3
    v_mov_b32 v223, 0xdddddddd
    v_add_u32 v219, s11, v219
    v_cndmask_b32 v217, v120, v217, vcc
    v_cndmask_b32 v218, v120, v218, vcc
    v_mov_b32 v221, 0
    v_and_b32 v3, 1, v2
    v_mul_u32_u24 v3, 33024, v3
    v_add_u32 v231, s56, v3
    v_bfe_u32 v208, v2, 1, 1
    v_lshl_add_u32 v231, v208, 4, v231
    v_mul_u32_u24 v208, 0x3f80, v208
    v_lshl_or_b32 v208, v208, 16, v208
    s_waitcnt vmcnt(6)
    ds_read_b128 v[144:147], v10 offset:0
    ds_read_b128 v[148:151], v11 offset:0
    ds_read_b128 v[152:155], v12 offset:0
    ds_read_b128 v[156:159], v13 offset:0
    s_barrier
    ds_read_b64_tr_b16 v[64:65], v14 offset:8192
    ds_read_b64_tr_b16 v[66:67], v14 offset:8448
    ds_read_b64_tr_b16 v[68:69], v14 offset:16384
    ds_read_b64_tr_b16 v[70:71], v14 offset:16640
    ds_read_b64_tr_b16 v[72:73], v14 offset:0
    ds_read_b64_tr_b16 v[74:75], v14 offset:256
    ds_read_b64_tr_b16 v[76:77], v14 offset:9216
    ds_read_b64_tr_b16 v[78:79], v14 offset:9472
    ds_read_b64_tr_b16 v[80:81], v14 offset:17408
    ds_read_b64_tr_b16 v[82:83], v14 offset:17664
    ds_read_b64_tr_b16 v[84:85], v14 offset:1024
    ds_read_b64_tr_b16 v[86:87], v14 offset:1280
    s_mov_b32 s69, 0x3eb8aa3b
    s_waitcnt lgkmcnt(10)
    v_mfma_f32_32x32x16_bf16 v[32:47], v[64:67], v[144:147], 0
    ds_read_b64_tr_b16 v[64:65], v14 offset:10240
    ds_read_b64_tr_b16 v[66:67], v14 offset:10496
    s_add_u32 m0, s55, 0
    s_nop 0
    buffer_load_dwordx4 v5, s[40:43], s65 offen offset:0 lds
    buffer_load_dwordx4 v6, s[40:43], s65 offen offset:1024 lds
    s_waitcnt lgkmcnt(10)
    v_mfma_f32_32x32x16_bf16 v[48:63], v[144:147], v[68:71], 0
    ds_read_b64_tr_b16 v[68:69], v14 offset:18432
    ds_read_b64_tr_b16 v[70:71], v14 offset:18688
    s_waitcnt lgkmcnt(10)
    v_mfma_f32_32x32x16_bf16 v[16:31], v[72:75], v[144:147], 0
    ds_read_b64_tr_b16 v[72:73], v14 offset:2048
    ds_read_b64_tr_b16 v[74:75], v14 offset:2304
    s_add_u32 m0, s55, 0
    s_nop 0
    buffer_load_dwordx4 v7, s[40:43], s65 offen offset:2048 lds
    buffer_load_dwordx4 v8, s[40:43], s65 offen offset:3072 lds
    s_waitcnt vmcnt(6)
    ds_read_b128 v[160:163], v10 offset:4096
    ds_read_b128 v[164:167], v11 offset:4096
    ds_read_b128 v[168:171], v12 offset:4096
    ds_read_b128 v[172:175], v13 offset:4096
    s_waitcnt lgkmcnt(14)
    v_mfma_f32_32x32x16_bf16 v[32:47], v[76:79], v[148:151], v[32:47]
    ds_read_b64_tr_b16 v[76:77], v14 offset:11264
    ds_read_b64_tr_b16 v[78:79], v14 offset:11520
    s_waitcnt lgkmcnt(14)
    v_mfma_f32_32x32x16_bf16 v[48:63], v[148:151], v[80:83], v[48:63]
    ds_read_b64_tr_b16 v[80:81], v14 offset:19456
    ds_read_b64_tr_b16 v[82:83], v14 offset:19712
    s_add_u32 m0, s54, 24576
    s_nop 0
    buffer_load_dwordx4 v9, s[44:47], s61 offen offset:0 lds
    s_waitcnt lgkmcnt(14)
    v_mfma_f32_32x32x16_bf16 v[16:31], v[84:87], v[148:151], v[16:31]
    ds_read_b64_tr_b16 v[84:85], v14 offset:3072
    ds_read_b64_tr_b16 v[86:87], v14 offset:3328
    s_waitcnt lgkmcnt(14)
    v_mfma_f32_32x32x16_bf16 v[32:47], v[64:67], v[152:155], v[32:47]
    ds_read_b64_tr_b16 v[64:65], v14 offset:12288
    ds_read_b64_tr_b16 v[66:67], v14 offset:12544
    s_add_u32 m0, s54, 31744
    s_nop 0
    buffer_load_dwordx4 v9, s[44:47], s61 offen offset:1024 lds
    v_mov_b32 v209, v208
    v_mov_b32 v210, v208
    v_mov_b32 v211, v208
    v_mov_b32 v212, -1
    s_waitcnt lgkmcnt(14)
    v_mfma_f32_32x32x16_bf16 v[48:63], v[152:155], v[68:71], v[48:63]
    ds_read_b64_tr_b16 v[68:69], v14 offset:20480
    ds_read_b64_tr_b16 v[70:71], v14 offset:20736
    v_mov_b32 v213, -1
    v_mov_b32 v214, -1
    v_mov_b32 v215, -1
    s_mov_b32 s14, 0
    s_waitcnt lgkmcnt(14)
    v_mfma_f32_32x32x16_bf16 v[16:31], v[72:75], v[152:155], v[16:31]
    ds_read_b64_tr_b16 v[72:73], v14 offset:4096
    ds_read_b64_tr_b16 v[74:75], v14 offset:4352
    s_add_u32 m0, s54, 38912
    s_nop 0
    buffer_load_dwordx4 v9, s[44:47], s61 offen offset:2048 lds
    s_mov_b32 s68, 0
    s_lshl_b32 s52, s3, 2
    s_add_u32 s52, s52, s35
    s_lshl_b32 s52, s52, 5
    s_waitcnt lgkmcnt(10)
    v_mfma_f32_32x32x16_bf16 v[32:47], v[76:79], v[156:159], v[32:47]
    ds_read_b64_tr_b16 v[76:77], v14 offset:13312
    ds_read_b64_tr_b16 v[78:79], v14 offset:13568
    s_add_u32 s52, s52, s5
    s_lshl_b32 s52, s52, 1
    s_add_u32 s52, s52, s34
    s_lshl_b32 s52, s52, 10
    s_waitcnt lgkmcnt(10)
    v_mfma_f32_32x32x16_bf16 v[48:63], v[156:159], v[80:83], v[48:63]
    ds_read_b64_tr_b16 v[80:81], v14 offset:21504
    ds_read_b64_tr_b16 v[82:83], v14 offset:21760
    s_add_u32 m0, s55, 3968
    s_nop 0
    buffer_load_dwordx4 v5, s[40:43], s65 offen offset:128 lds
    buffer_load_dwordx4 v6, s[40:43], s65 offen offset:1152 lds
    s_add_u32 s52, s52, 8388608
    s_add_u32 s53, s52, 32768
    v_lshrrev_b32 v120, 4, v2
    v_and_b32 v121, 15, v2
    s_waitcnt lgkmcnt(10)
    v_mfma_f32_32x32x16_bf16 v[16:31], v[84:87], v[156:159], v[16:31]
    ds_read_b64_tr_b16 v[84:85], v14 offset:5120
    ds_read_b64_tr_b16 v[86:87], v14 offset:5376
    v_lshlrev_b32 v242, 4, v121
    v_lshl_add_u32 v242, v120, 9, v242
    v_lshlrev_b32 v241, 11, v1
    v_bfe_u32 v3, v2, 4, 1
    s_waitcnt lgkmcnt(10)
    v_mfma_f32_32x32x16_bf16 v[32:47], v[64:67], v[160:163], v[32:47]
    ds_read_b64_tr_b16 v[64:65], v14 offset:14336
    ds_read_b64_tr_b16 v[66:67], v14 offset:14592
    s_add_u32 m0, s55, 3968
    s_nop 0
    buffer_load_dwordx4 v7, s[40:43], s65 offen offset:2176 lds
    buffer_load_dwordx4 v8, s[40:43], s65 offen offset:3200 lds
    v_lshl_add_u32 v241, v3, 9, v241
    v_lshl_add_u32 v241, v3, 6, v241
    v_bfe_u32 v3, v2, 2, 2
    v_lshl_add_u32 v241, v3, 7, v241
    s_waitcnt lgkmcnt(10)
    v_mfma_f32_32x32x16_bf16 v[48:63], v[160:163], v[68:71], v[48:63]
    ds_read_b64_tr_b16 v[68:69], v14 offset:22528
    ds_read_b64_tr_b16 v[70:71], v14 offset:22784
    v_bfe_u32 v3, v2, 3, 1
    v_lshl_add_u32 v241, v3, 5, v241
    v_and_b32 v3, 3, v2
    v_lshl_add_u32 v241, v3, 3, v241
    s_waitcnt lgkmcnt(10)
    v_mfma_f32_32x32x16_bf16 v[16:31], v[72:75], v[160:163], v[16:31]
    ds_read_b64_tr_b16 v[72:73], v14 offset:6144
    ds_read_b64_tr_b16 v[74:75], v14 offset:6400
    s_mul_i32 s12, s10, 2304
    s_add_u32 s12, s12, 69632
    v_mul_u32_u24 v243, 144, v121
    v_lshl_add_u32 v243, v120, 3, v243
    s_waitcnt vmcnt(7)
    ds_read_b128 v[88:91], v10 offset:0
    ds_read_b128 v[92:95], v11 offset:0
    ds_read_b128 v[96:99], v12 offset:0
    ds_read_b128 v[100:103], v13 offset:0
    s_waitcnt lgkmcnt(14)
    v_mfma_f32_32x32x16_bf16 v[32:47], v[76:79], v[164:167], v[32:47]
    ds_read_b64_tr_b16 v[76:77], v14 offset:15360
    ds_read_b64_tr_b16 v[78:79], v14 offset:15616
    v_add_u32 v243, s12, v243
    v_lshrrev_b32 v3, 3, v2
    v_and_b32 v121, 7, v2
    v_mul_u32_u24 v244, 144, v3
    s_waitcnt lgkmcnt(14)
    v_mfma_f32_32x32x16_bf16 v[48:63], v[164:167], v[80:83], v[48:63]
    ds_read_b64_tr_b16 v[80:81], v14 offset:23552
    ds_read_b64_tr_b16 v[82:83], v14 offset:23808
    s_waitcnt lgkmcnt(4)
    s_add_u32 m0, s55, 0
    s_nop 0
    buffer_load_dwordx4 v5, s[40:43], s66 offen offset:0 lds
    buffer_load_dwordx4 v6, s[40:43], s66 offen offset:1024 lds
    v_lshl_add_u32 v244, v121, 4, v244
    v_add_u32 v244, s12, v244
    v_lshlrev_b32 v245, 11, v3
    v_lshl_add_u32 v245, v121, 4, v245
    v_mfma_f32_32x32x16_bf16 v[16:31], v[84:87], v[164:167], v[16:31]
    ds_read_b64_tr_b16 v[84:85], v14 offset:7168
    ds_read_b64_tr_b16 v[86:87], v14 offset:7424
    v_lshlrev_b32 v120, 1, v120
    v_xor_b32 v120, v120, v2
    v_and_b32 v120, 7, v120
    v_lshlrev_b32 v3, 10, v3
    s_waitcnt vmcnt(6)
    s_barrier
    v_mfma_f32_32x32x16_bf16 v[32:47], v[64:67], v[168:171], v[32:47]
    ds_read_b64_tr_b16 v[64:65], v14 offset:32768
    ds_read_b64_tr_b16 v[66:67], v14 offset:33024
    s_add_u32 m0, s55, 0
    s_nop 0
    buffer_load_dwordx4 v7, s[40:43], s66 offen offset:2048 lds
    buffer_load_dwordx4 v8, s[40:43], s66 offen offset:3072 lds
    v_lshl_add_u32 v246, v120, 4, v3
    v_mov_b32 v176, 0
    v_mov_b32 v177, 0
    v_mov_b32 v178, 0
    v_mfma_f32_32x32x16_bf16 v[48:63], v[168:171], v[68:71], v[48:63]
    ds_read_b64_tr_b16 v[68:69], v14 offset:40960
    ds_read_b64_tr_b16 v[70:71], v14 offset:41216
    v_mov_b32 v179, 0
    v_mov_b32 v180, 0
    v_mov_b32 v181, 0
    v_mov_b32 v182, 0
    v_mfma_f32_32x32x16_bf16 v[16:31], v[72:75], v[168:171], v[16:31]
    ds_read_b64_tr_b16 v[72:73], v14 offset:24576
    ds_read_b64_tr_b16 v[74:75], v14 offset:24832
    v_mov_b32 v183, 0
    v_mov_b32 v184, 0
    v_mov_b32 v185, 0
    v_mov_b32 v186, 0
    s_waitcnt lgkmcnt(10)
    v_mfma_f32_32x32x16_bf16 v[32:47], v[76:79], v[172:175], v[32:47]
    ds_read_b64_tr_b16 v[76:77], v14 offset:33792
    ds_read_b64_tr_b16 v[78:79], v14 offset:34048
    s_add_u32 m0, s54, 49152
    s_nop 0
    buffer_load_dwordx4 v9, s[44:47], s62 offen offset:0 lds
    v_mov_b32 v187, 0
    v_mov_b32 v188, 0
    v_mov_b32 v189, 0
    v_mov_b32 v190, 0
    s_waitcnt lgkmcnt(10)
    v_mfma_f32_32x32x16_bf16 v[48:63], v[172:175], v[80:83], v[48:63]
    ds_read_b64_tr_b16 v[80:81], v14 offset:41984
    ds_read_b64_tr_b16 v[82:83], v14 offset:42240
    v_mov_b32 v191, 0
    v_mov_b32 v192, 0
    v_mov_b32 v193, 0
    v_mov_b32 v194, 0
    s_waitcnt lgkmcnt(10)
    v_mfma_f32_32x32x16_bf16 v[16:31], v[84:87], v[172:175], v[16:31]
    ds_read_b64_tr_b16 v[84:85], v14 offset:25600
    ds_read_b64_tr_b16 v[86:87], v14 offset:25856
    s_add_u32 m0, s54, 56320
    s_nop 0
    buffer_load_dwordx4 v9, s[44:47], s62 offen offset:1024 lds
    v_mov_b32 v195, 0
    v_mov_b32 v196, 0
    v_mov_b32 v197, 0
    v_mov_b32 v198, 0
    s_waitcnt lgkmcnt(10)
    v_mfma_f32_32x32x16_bf16 v[32:47], v[64:67], v[88:91], v[32:47]
    ds_read_b64_tr_b16 v[64:65], v14 offset:34816
    ds_read_b64_tr_b16 v[66:67], v14 offset:35072
    v_mov_b32 v199, 0
    v_mov_b32 v200, 0
    v_mov_b32 v201, 0
    v_mov_b32 v202, 0
    s_waitcnt lgkmcnt(10)
    v_mfma_f32_32x32x16_bf16 v[48:63], v[88:91], v[68:71], v[48:63]
    ds_read_b64_tr_b16 v[68:69], v14 offset:43008
    ds_read_b64_tr_b16 v[70:71], v14 offset:43264
    s_add_u32 m0, s54, 63488
    s_nop 0
    buffer_load_dwordx4 v9, s[44:47], s62 offen offset:2048 lds
    v_mov_b32 v203, 0
    v_mov_b32 v204, 0
    v_mov_b32 v205, 0
    v_mov_b32 v206, 0
    s_waitcnt lgkmcnt(10)
    v_mfma_f32_32x32x16_bf16 v[16:31], v[72:75], v[88:91], v[16:31]
    ds_read_b64_tr_b16 v[72:73], v14 offset:26624
    ds_read_b64_tr_b16 v[74:75], v14 offset:26880
    v_mov_b32 v207, 0
    s_waitcnt vmcnt(7)
    ds_read_b128 v[104:107], v10 offset:4096
    ds_read_b128 v[108:111], v11 offset:4096
    ds_read_b128 v[112:115], v12 offset:4096
    ds_read_b128 v[116:119], v13 offset:4096
    s_waitcnt lgkmcnt(14)
    v_mfma_f32_32x32x16_bf16 v[32:47], v[76:79], v[92:95], v[32:47]
    ds_read_b64_tr_b16 v[76:77], v14 offset:35840
    ds_read_b64_tr_b16 v[78:79], v14 offset:36096
    s_waitcnt lgkmcnt(14)
    v_mfma_f32_32x32x16_bf16 v[48:63], v[92:95], v[80:83], v[48:63]
    ds_read_b64_tr_b16 v[80:81], v14 offset:44032
    ds_read_b64_tr_b16 v[82:83], v14 offset:44288
    s_waitcnt lgkmcnt(4)
    s_add_u32 m0, s55, 3968
    s_nop 0
    buffer_load_dwordx4 v5, s[40:43], s66 offen offset:128 lds
    buffer_load_dwordx4 v6, s[40:43], s66 offen offset:1152 lds
    v_mfma_f32_32x32x16_bf16 v[16:31], v[84:87], v[92:95], v[16:31]
    ds_read_b64_tr_b16 v[84:85], v14 offset:27648
    ds_read_b64_tr_b16 v[86:87], v14 offset:27904
    v_mfma_f32_32x32x16_bf16 v[32:47], v[64:67], v[96:99], v[32:47]
    ds_read_b64_tr_b16 v[64:65], v14 offset:36864
    ds_read_b64_tr_b16 v[66:67], v14 offset:37120
    s_add_u32 m0, s55, 3968
    s_nop 0
    buffer_load_dwordx4 v7, s[40:43], s66 offen offset:2176 lds
    buffer_load_dwordx4 v8, s[40:43], s66 offen offset:3200 lds
    v_mfma_f32_32x32x16_bf16 v[48:63], v[96:99], v[68:71], v[48:63]
    ds_read_b64_tr_b16 v[68:69], v14 offset:45056
    ds_read_b64_tr_b16 v[70:71], v14 offset:45312
    v_mfma_f32_32x32x16_bf16 v[16:31], v[72:75], v[96:99], v[16:31]
    ds_read_b64_tr_b16 v[72:73], v14 offset:28672
    ds_read_b64_tr_b16 v[74:75], v14 offset:28928
    s_waitcnt lgkmcnt(10)
    v_mfma_f32_32x32x16_bf16 v[32:47], v[76:79], v[100:103], v[32:47]
    ds_read_b64_tr_b16 v[76:77], v14 offset:37888
    ds_read_b64_tr_b16 v[78:79], v14 offset:38144
    s_waitcnt lgkmcnt(10)
    v_mfma_f32_32x32x16_bf16 v[48:63], v[100:103], v[80:83], v[48:63]
    ds_read_b64_tr_b16 v[80:81], v14 offset:46080
    ds_read_b64_tr_b16 v[82:83], v14 offset:46336
    s_waitcnt lgkmcnt(10)
    v_mfma_f32_32x32x16_bf16 v[16:31], v[84:87], v[100:103], v[16:31]
    ds_read_b64_tr_b16 v[84:85], v14 offset:29696
    ds_read_b64_tr_b16 v[86:87], v14 offset:29952
    s_waitcnt lgkmcnt(10)
    v_mfma_f32_32x32x16_bf16 v[32:47], v[64:67], v[104:107], v[32:47]
    ds_read_b64_tr_b16 v[64:65], v14 offset:38912
    ds_read_b64_tr_b16 v[66:67], v14 offset:39168
    s_waitcnt lgkmcnt(10)
    v_mfma_f32_32x32x16_bf16 v[48:63], v[104:107], v[68:71], v[48:63]
    ds_read_b64_tr_b16 v[68:69], v14 offset:47104
    ds_read_b64_tr_b16 v[70:71], v14 offset:47360
    s_waitcnt lgkmcnt(10)
    v_mfma_f32_32x32x16_bf16 v[16:31], v[72:75], v[104:107], v[16:31]
    ds_read_b64_tr_b16 v[72:73], v14 offset:30720
    ds_read_b64_tr_b16 v[74:75], v14 offset:30976
    s_waitcnt vmcnt(7)
    ds_read_b128 v[144:147], v10 offset:0
    ds_read_b128 v[148:151], v11 offset:0
    ds_read_b128 v[152:155], v12 offset:0
    ds_read_b128 v[156:159], v13 offset:0
    s_waitcnt lgkmcnt(14)
    v_mfma_f32_32x32x16_bf16 v[32:47], v[76:79], v[108:111], v[32:47]
    ds_read_b64_tr_b16 v[76:77], v14 offset:39936
    ds_read_b64_tr_b16 v[78:79], v14 offset:40192
    s_waitcnt lgkmcnt(14)
    v_mfma_f32_32x32x16_bf16 v[48:63], v[108:111], v[80:83], v[48:63]
    ds_read_b64_tr_b16 v[80:81], v14 offset:48128
    ds_read_b64_tr_b16 v[82:83], v14 offset:48384
    s_waitcnt lgkmcnt(4)
    s_add_u32 m0, s55, 0
    s_nop 0
    buffer_load_dwordx4 v5, s[40:43], s67 offen offset:0 lds
    buffer_load_dwordx4 v6, s[40:43], s67 offen offset:1024 lds
    v_mfma_f32_32x32x16_bf16 v[16:31], v[84:87], v[108:111], v[16:31]
    ds_read_b64_tr_b16 v[84:85], v14 offset:31744
    ds_read_b64_tr_b16 v[86:87], v14 offset:32000
    s_waitcnt vmcnt(6)
    s_barrier
    v_mfma_f32_32x32x16_bf16 v[32:47], v[64:67], v[112:115], v[32:47]
    ds_read_b64_tr_b16 v[64:65], v15 offset:8192
    ds_read_b64_tr_b16 v[66:67], v15 offset:8448
    s_add_u32 m0, s55, 0
    s_nop 0
    buffer_load_dwordx4 v7, s[40:43], s67 offen offset:2048 lds
    buffer_load_dwordx4 v8, s[40:43], s67 offen offset:3072 lds
    v_mfma_f32_32x32x16_bf16 v[48:63], v[112:115], v[68:71], v[48:63]
    ds_read_b64_tr_b16 v[68:69], v15 offset:16384
    ds_read_b64_tr_b16 v[70:71], v15 offset:16640
    v_mfma_f32_32x32x16_bf16 v[16:31], v[72:75], v[112:115], v[16:31]
    ds_read_b64_tr_b16 v[72:73], v15 offset:0
    ds_read_b64_tr_b16 v[74:75], v15 offset:256
    s_waitcnt lgkmcnt(10)
    v_mfma_f32_32x32x16_bf16 v[32:47], v[76:79], v[116:119], v[32:47]
    ds_read_b64_tr_b16 v[76:77], v15 offset:9216
    ds_read_b64_tr_b16 v[78:79], v15 offset:9472
    s_add_u32 m0, s54, 73728
    s_nop 0
    buffer_load_dwordx4 v9, s[44:47], s63 offen offset:0 lds
    s_waitcnt lgkmcnt(10)
    v_mfma_f32_32x32x16_bf16 v[48:63], v[116:119], v[80:83], v[48:63]
    ds_read_b64_tr_b16 v[80:81], v15 offset:17408
    ds_read_b64_tr_b16 v[82:83], v15 offset:17664
    s_waitcnt lgkmcnt(10)
    v_mfma_f32_32x32x16_bf16 v[16:31], v[84:87], v[116:119], v[16:31]
    ds_read_b64_tr_b16 v[84:85], v15 offset:1024
    ds_read_b64_tr_b16 v[86:87], v15 offset:1280
    s_add_u32 m0, s54, 80896
    s_nop 0
    buffer_load_dwordx4 v9, s[44:47], s63 offen offset:1024 lds
    s_waitcnt lgkmcnt(10)
    v_mfma_f32_32x32x16_bf16 v[32:47], v[64:67], v[144:147], v[32:47]
    ds_read_b64_tr_b16 v[64:65], v15 offset:10240
    ds_read_b64_tr_b16 v[66:67], v15 offset:10496
    s_waitcnt lgkmcnt(10)
    v_mfma_f32_32x32x16_bf16 v[48:63], v[144:147], v[68:71], v[48:63]
    ds_read_b64_tr_b16 v[68:69], v15 offset:18432
    ds_read_b64_tr_b16 v[70:71], v15 offset:18688
    s_add_u32 m0, s54, 88064
    s_nop 0
    buffer_load_dwordx4 v9, s[44:47], s63 offen offset:2048 lds
    s_waitcnt lgkmcnt(10)
    v_mfma_f32_32x32x16_bf16 v[16:31], v[72:75], v[144:147], v[16:31]
    ds_read_b64_tr_b16 v[72:73], v15 offset:2048
    ds_read_b64_tr_b16 v[74:75], v15 offset:2304
    s_waitcnt vmcnt(7)
    ds_read_b128 v[160:163], v10 offset:4096
    ds_read_b128 v[164:167], v11 offset:4096
    ds_read_b128 v[168:171], v12 offset:4096
    ds_read_b128 v[172:175], v13 offset:4096
    s_waitcnt lgkmcnt(14)
    v_mfma_f32_32x32x16_bf16 v[32:47], v[76:79], v[148:151], v[32:47]
    ds_read_b64_tr_b16 v[76:77], v15 offset:11264
    ds_read_b64_tr_b16 v[78:79], v15 offset:11520
    s_waitcnt lgkmcnt(14)
    v_mfma_f32_32x32x16_bf16 v[48:63], v[148:151], v[80:83], v[48:63]
    ds_read_b64_tr_b16 v[80:81], v15 offset:19456
    ds_read_b64_tr_b16 v[82:83], v15 offset:19712
    s_waitcnt lgkmcnt(4)
    s_add_u32 m0, s55, 3968
    s_nop 0
    buffer_load_dwordx4 v5, s[40:43], s67 offen offset:128 lds
    buffer_load_dwordx4 v6, s[40:43], s67 offen offset:1152 lds
    v_mfma_f32_32x32x16_bf16 v[16:31], v[84:87], v[148:151], v[16:31]
    ds_read_b64_tr_b16 v[84:85], v15 offset:3072
    ds_read_b64_tr_b16 v[86:87], v15 offset:3328
    v_mfma_f32_32x32x16_bf16 v[32:47], v[64:67], v[152:155], v[32:47]
    ds_read_b64_tr_b16 v[64:65], v15 offset:12288
    ds_read_b64_tr_b16 v[66:67], v15 offset:12544
    s_add_u32 m0, s55, 3968
    s_nop 0
    buffer_load_dwordx4 v7, s[40:43], s67 offen offset:2176 lds
    buffer_load_dwordx4 v8, s[40:43], s67 offen offset:3200 lds
    v_mfma_f32_32x32x16_bf16 v[48:63], v[152:155], v[68:71], v[48:63]
    ds_read_b64_tr_b16 v[68:69], v15 offset:20480
    ds_read_b64_tr_b16 v[70:71], v15 offset:20736
    v_mfma_f32_32x32x16_bf16 v[16:31], v[72:75], v[152:155], v[16:31]
    ds_read_b64_tr_b16 v[72:73], v15 offset:4096
    ds_read_b64_tr_b16 v[74:75], v15 offset:4352
    s_waitcnt lgkmcnt(10)
    v_mfma_f32_32x32x16_bf16 v[32:47], v[76:79], v[156:159], v[32:47]
    ds_read_b64_tr_b16 v[76:77], v15 offset:13312
    ds_read_b64_tr_b16 v[78:79], v15 offset:13568
    s_waitcnt lgkmcnt(10)
    v_mfma_f32_32x32x16_bf16 v[48:63], v[156:159], v[80:83], v[48:63]
    ds_read_b64_tr_b16 v[80:81], v15 offset:21504
    ds_read_b64_tr_b16 v[82:83], v15 offset:21760
    s_waitcnt lgkmcnt(10)
    v_mfma_f32_32x32x16_bf16 v[16:31], v[84:87], v[156:159], v[16:31]
    ds_read_b64_tr_b16 v[84:85], v15 offset:5120
    ds_read_b64_tr_b16 v[86:87], v15 offset:5376
    s_waitcnt lgkmcnt(10)
    v_mfma_f32_32x32x16_bf16 v[32:47], v[64:67], v[160:163], v[32:47]
    ds_read_b64_tr_b16 v[64:65], v15 offset:14336
    ds_read_b64_tr_b16 v[66:67], v15 offset:14592
    s_waitcnt lgkmcnt(10)
    v_mfma_f32_32x32x16_bf16 v[48:63], v[160:163], v[68:71], v[48:63]
    ds_read_b64_tr_b16 v[68:69], v15 offset:22528
    ds_read_b64_tr_b16 v[70:71], v15 offset:22784
    s_waitcnt lgkmcnt(10)
    v_mfma_f32_32x32x16_bf16 v[16:31], v[72:75], v[160:163], v[16:31]
    ds_read_b64_tr_b16 v[72:73], v15 offset:6144
    ds_read_b64_tr_b16 v[74:75], v15 offset:6400
    s_waitcnt lgkmcnt(10)
    v_mfma_f32_32x32x16_bf16 v[32:47], v[76:79], v[164:167], v[32:47]
    ds_read_b64_tr_b16 v[76:77], v15 offset:15360
    ds_read_b64_tr_b16 v[78:79], v15 offset:15616
    s_waitcnt lgkmcnt(10)
    v_mfma_f32_32x32x16_bf16 v[48:63], v[164:167], v[80:83], v[48:63]
    ds_read_b64_tr_b16 v[80:81], v15 offset:23552
    ds_read_b64_tr_b16 v[82:83], v15 offset:23808
    s_waitcnt lgkmcnt(10)
    v_mfma_f32_32x32x16_bf16 v[16:31], v[84:87], v[164:167], v[16:31]
    ds_read_b64_tr_b16 v[84:85], v15 offset:7168
    ds_read_b64_tr_b16 v[86:87], v15 offset:7424
    s_waitcnt vmcnt(7)
    ds_read_b128 v[88:91], v10 offset:0
    ds_read_b128 v[92:95], v11 offset:0
    ds_read_b128 v[96:99], v12 offset:0
    ds_read_b128 v[100:103], v13 offset:0
    s_waitcnt vmcnt(4)
    s_waitcnt lgkmcnt(4)
    s_barrier
    v_mfma_f32_32x32x16_bf16 v[32:47], v[64:67], v[168:171], v[32:47]
    ds_read_b64_tr_b16 v[64:65], v15 offset:32768
    ds_read_b64_tr_b16 v[66:67], v15 offset:33024
    v_mfma_f32_32x32x16_bf16 v[48:63], v[168:171], v[68:71], v[48:63]
    ds_read_b64_tr_b16 v[68:69], v15 offset:24576
    ds_read_b64_tr_b16 v[70:71], v15 offset:24832
    v_mfma_f32_32x32x16_bf16 v[16:31], v[72:75], v[168:171], v[16:31]
    ds_read_b64_tr_b16 v[72:73], v15 offset:33792
    ds_read_b64_tr_b16 v[74:75], v15 offset:34048
    v_mfma_f32_32x32x16_bf16 v[32:47], v[76:79], v[172:175], v[32:47]
    ds_read_b64_tr_b16 v[76:77], v15 offset:25600
    ds_read_b64_tr_b16 v[78:79], v15 offset:25856
    v_mfma_f32_32x32x16_bf16 v[48:63], v[172:175], v[80:83], v[48:63]
    ds_read_b64_tr_b16 v[80:81], v15 offset:34816
    ds_read_b64_tr_b16 v[82:83], v15 offset:35072
    v_mfma_f32_32x32x16_bf16 v[16:31], v[84:87], v[172:175], v[16:31]
    ds_read_b64_tr_b16 v[84:85], v15 offset:26624
    ds_read_b64_tr_b16 v[86:87], v15 offset:26880
    s_waitcnt lgkmcnt(10)
    v_mfma_f32_32x32x16_bf16 v[32:47], v[64:67], v[88:91], v[32:47]
    ds_read_b64_tr_b16 v[64:65], v15 offset:35840
    ds_read_b64_tr_b16 v[66:67], v15 offset:36096
    s_waitcnt lgkmcnt(10)
    v_mfma_f32_32x32x16_bf16 v[16:31], v[68:71], v[88:91], v[16:31]
    ds_read_b64_tr_b16 v[68:69], v15 offset:27648
    ds_read_b64_tr_b16 v[70:71], v15 offset:27904
    s_waitcnt lgkmcnt(10)
    v_mfma_f32_32x32x16_bf16 v[32:47], v[72:75], v[92:95], v[32:47]
    ds_read_b64_tr_b16 v[72:73], v15 offset:36864
    ds_read_b64_tr_b16 v[74:75], v15 offset:37120
    s_waitcnt lgkmcnt(10)
    v_mfma_f32_32x32x16_bf16 v[16:31], v[76:79], v[92:95], v[16:31]
    ds_read_b64_tr_b16 v[76:77], v15 offset:28672
    ds_read_b64_tr_b16 v[78:79], v15 offset:28928
    s_waitcnt vmcnt(0)
    ds_read_b128 v[104:107], v10 offset:4096
    ds_read_b128 v[108:111], v11 offset:4096
    ds_read_b128 v[112:115], v12 offset:4096
    ds_read_b128 v[116:119], v13 offset:4096
    s_waitcnt lgkmcnt(14)
    v_mfma_f32_32x32x16_bf16 v[32:47], v[80:83], v[96:99], v[32:47]
    ds_read_b64_tr_b16 v[80:81], v15 offset:37888
    ds_read_b64_tr_b16 v[82:83], v15 offset:38144
    s_waitcnt lgkmcnt(14)
    v_mfma_f32_32x32x16_bf16 v[16:31], v[84:87], v[96:99], v[16:31]
    ds_read_b64_tr_b16 v[84:85], v15 offset:29696
    ds_read_b64_tr_b16 v[86:87], v15 offset:29952
    s_waitcnt lgkmcnt(14)
    v_mfma_f32_32x32x16_bf16 v[32:47], v[64:67], v[100:103], v[32:47]
    ds_read_b64_tr_b16 v[64:65], v15 offset:38912
    ds_read_b64_tr_b16 v[66:67], v15 offset:39168
    s_waitcnt lgkmcnt(14)
    v_mfma_f32_32x32x16_bf16 v[16:31], v[68:71], v[100:103], v[16:31]
    ds_read_b64_tr_b16 v[68:69], v15 offset:30720
    ds_read_b64_tr_b16 v[70:71], v15 offset:30976
    s_waitcnt lgkmcnt(11)
    v_mfma_f32_32x32x16_bf16 v[32:47], v[72:75], v[104:107], v[32:47]
    ds_read_b64_tr_b16 v[72:73], v15 offset:39936
    ds_read_b64_tr_b16 v[74:75], v15 offset:40192
    v_mfma_f32_32x32x16_bf16 v[16:31], v[76:79], v[104:107], v[16:31]
    ds_read_b64_tr_b16 v[76:77], v15 offset:31744
    ds_read_b64_tr_b16 v[78:79], v15 offset:32000
    s_waitcnt lgkmcnt(10)
    v_mfma_f32_32x32x16_bf16 v[32:47], v[80:83], v[108:111], v[32:47]
    ds_read_b64_tr_b16 v[80:81], v15 offset:40960
    ds_read_b64_tr_b16 v[82:83], v15 offset:41216
    s_waitcnt lgkmcnt(10)
    v_mfma_f32_32x32x16_bf16 v[16:31], v[84:87], v[108:111], v[16:31]
    ds_read_b64_tr_b16 v[84:85], v15 offset:41984
    ds_read_b64_tr_b16 v[86:87], v15 offset:42240
    s_waitcnt lgkmcnt(10)
    v_mfma_f32_32x32x16_bf16 v[32:47], v[64:67], v[112:115], v[32:47]
    ds_read_b64_tr_b16 v[64:65], v15 offset:43008
    ds_read_b64_tr_b16 v[66:67], v15 offset:43264
    s_waitcnt lgkmcnt(10)
    v_mfma_f32_32x32x16_bf16 v[16:31], v[68:71], v[112:115], v[16:31]
    ds_read_b64_tr_b16 v[68:69], v15 offset:44032
    ds_read_b64_tr_b16 v[70:71], v15 offset:44288
    s_waitcnt lgkmcnt(10)
    v_mfma_f32_32x32x16_bf16 v[32:47], v[72:75], v[116:119], v[32:47]
    ds_read_b64_tr_b16 v[72:73], v15 offset:45056
    ds_read_b64_tr_b16 v[74:75], v15 offset:45312
    s_waitcnt lgkmcnt(10)
    v_mfma_f32_32x32x16_bf16 v[16:31], v[76:79], v[116:119], v[16:31]
    ds_read_b64_tr_b16 v[76:77], v15 offset:46080
    ds_read_b64_tr_b16 v[78:79], v15 offset:46336
    s_waitcnt lgkmcnt(10)
    v_mfma_f32_32x32x16_bf16 v[48:63], v[88:91], v[80:83], v[48:63]
    ds_read_b64_tr_b16 v[80:81], v15 offset:47104
    ds_read_b64_tr_b16 v[82:83], v15 offset:47360
    s_nop 2
    v_cvt_pk_bf16_f32 v120, v32, v33
    v_cvt_pk_bf16_f32 v121, v34, v35
    v_cvt_pk_bf16_f32 v122, v36, v37
    v_cvt_pk_bf16_f32 v123, v38, v39
    v_cvt_pk_bf16_f32 v124, v40, v41
    v_cvt_pk_bf16_f32 v125, v42, v43
    v_cvt_pk_bf16_f32 v126, v44, v45
    v_cvt_pk_bf16_f32 v127, v46, v47
    v_mul_f32 v16, s69, v16
    s_waitcnt lgkmcnt(10)
    v_mfma_f32_32x32x16_bf16 v[48:63], v[92:95], v[84:87], v[48:63]
    ds_read_b64_tr_b16 v[84:85], v15 offset:48128
    ds_read_b64_tr_b16 v[86:87], v15 offset:48384
    v_mul_f32 v17, s69, v17
    v_mul_f32 v18, s69, v18
    v_mul_f32 v19, s69, v19
    v_mul_f32 v20, s69, v20
    v_mul_f32 v21, s69, v21
    v_mul_f32 v22, s69, v22
    v_mul_f32 v23, s69, v23
    v_mul_f32 v24, s69, v24
    v_mul_f32 v25, s69, v25
    s_waitcnt lgkmcnt(10)
    v_mfma_f32_32x32x16_bf16 v[48:63], v[96:99], v[64:67], v[48:63]
    v_mul_f32 v26, s69, v26
    v_mul_f32 v27, s69, v27
    v_mul_f32 v28, s69, v28
    v_mul_f32 v29, s69, v29
    v_mul_f32 v30, s69, v30
    v_mul_f32 v31, s69, v31
    v_cvt_pk_bf16_f32 v128, v16, v17
    v_cvt_pk_bf16_f32 v129, v18, v19
    v_cvt_pk_bf16_f32 v130, v20, v21
    s_waitcnt lgkmcnt(8)
    v_mfma_f32_32x32x16_bf16 v[48:63], v[100:103], v[68:71], v[48:63]
    v_cvt_pk_bf16_f32 v131, v22, v23
    v_cvt_pk_bf16_f32 v132, v24, v25
    v_cvt_pk_bf16_f32 v133, v26, v27
    v_cvt_pk_bf16_f32 v134, v28, v29
    v_cvt_pk_bf16_f32 v135, v30, v31
    ds_write_b128 v226, v[120:123]
    ds_write_b128 v226, v[124:127] offset:2048
    v_mfma_f32_32x32x16_bf16 v[144:159], v[120:123], v[128:131], 0
    v_mfma_f32_32x32x16_bf16 v[160:175], v[124:127], v[132:135], 0
    s_waitcnt lgkmcnt(8)
    v_mfma_f32_32x32x16_bf16 v[48:63], v[104:107], v[72:75], v[48:63]
    ds_write_b128 v225, v[128:131] offset:5120
    ds_write_b128 v225, v[132:135] offset:6144
    buffer_store_dwordx4 v[120:123], v228, s[48:51], s58 offen sc1
    buffer_store_dwordx4 v[124:127], v228, s[48:51], s58 offen offset:2048 sc1
    s_mov_b64 exec, 15
    ds_write_b128 v231, v[208:211] offset:4096
    s_mov_b64 exec, -1
    ds_write_b32 v219, v221
    s_nop 3
    s_waitcnt lgkmcnt(10)
    v_mfma_f32_32x32x16_bf16 v[48:63], v[108:111], v[76:79], v[48:63]
    v_max3_f32 v237, v144, v145, v146
    v_max3_f32 v237, v237, v147, v148
    v_max3_f32 v237, v237, v149, v150
    v_max3_f32 v237, v237, v151, v152
    v_max3_f32 v237, v237, v153, v154
    v_max3_f32 v237, v237, v155, v156
    v_max3_f32 v237, v237, v157, v158
    v_max_f32 v237, v237, v159
    v_max3_f32 v238, v160, v161, v162
    s_waitcnt lgkmcnt(8)
    v_mfma_f32_32x32x16_bf16 v[48:63], v[112:115], v[80:83], v[48:63]
    v_max3_f32 v238, v238, v163, v164
    v_max3_f32 v238, v238, v165, v166
    v_max3_f32 v238, v238, v167, v168
    v_max3_f32 v238, v238, v169, v170
    v_max3_f32 v238, v238, v171, v172
    v_max3_f32 v238, v238, v173, v174
    v_max_f32 v238, v238, v175
    v_mov_b32 v1, v237
    v_mov_b32 v3, v238
    s_waitcnt lgkmcnt(6)
    v_mfma_f32_32x32x16_bf16 v[48:63], v[116:119], v[84:87], v[48:63]
    s_nop 1
    v_permlane32_swap_b32 v237, v1
    v_permlane32_swap_b32 v238, v3
    s_nop 1
    v_max_f32 v237, v237, v1
    v_max_f32 v238, v238, v3
    ds_write_b32 v248, v237 offset:7168
    ds_write_b32 v248, v238 offset:7424
    s_nop 3
    v_cvt_pk_bf16_f32 v136, v48, v49
    v_cvt_pk_bf16_f32 v137, v50, v51
    v_cvt_pk_bf16_f32 v138, v52, v53
    v_cvt_pk_bf16_f32 v139, v54, v55
    v_cvt_pk_bf16_f32 v140, v56, v57
    v_cvt_pk_bf16_f32 v141, v58, v59
    v_cvt_pk_bf16_f32 v142, v60, v61
    v_cvt_pk_bf16_f32 v143, v62, v63
    ds_write_b128 v227, v[136:139]
    ds_write_b128 v227, v[140:143] offset:512
    buffer_store_dwordx4 v[136:139], v229, s[48:51], s58 offen sc1
    buffer_store_dwordx4 v[140:143], v229, s[48:51], s58 offen offset:512 sc1
    v_add_u32 v231, 66048, v231
    v_mov_b32 v44, 0
    v_mov_b32 v45, 0
    v_mov_b32 v46, 0
    v_mov_b32 v47, 0
    v_mov_b32 v168, 0
    v_mov_b32 v169, 0
    v_mov_b32 v170, 0
    v_mov_b32 v171, 0
    v_mov_b32 v172, 0
    v_mov_b32 v173, 0
    v_mov_b32 v174, 0
    v_mov_b32 v175, 0
    s_mov_b32 s15, 33024
    s_add_u32 s63, s56, 33024
    s_waitcnt lgkmcnt(0)
    s_barrier
    ds_read_b32 v237, v247 offset:2048
    ds_read_b128 v[16:19], v224
    ds_read_b128 v[24:27], v216
    ds_read_b32 v238, v247 offset:10240
    ds_read_b128 v[20:23], v224 offset:8192
    ds_read_b128 v[32:35], v217
    ds_read_b128 v[36:39], v218
    s_mov_b64 exec, 5
    ds_write_b128 v231, v[208:211] offset:4096
    s_mov_b64 exec, -1
    s_waitcnt lgkmcnt(7)
    v_sub_f32 v64, 0, v237
    v_sub_f32 v65, 0, v237
    v_sub_f32 v66, 0, v237
    v_sub_f32 v67, 0, v237
    v_sub_f32 v68, 0, v237
    v_sub_f32 v69, 0, v237
    v_sub_f32 v70, 0, v237
    v_sub_f32 v71, 0, v237
    v_sub_f32 v72, 0, v237
    v_sub_f32 v73, 0, v237
    v_sub_f32 v74, 0, v237
    v_sub_f32 v75, 0, v237
    v_sub_f32 v76, 0, v237
    v_sub_f32 v77, 0, v237
    v_sub_f32 v78, 0, v237
    v_sub_f32 v79, 0, v237
    s_waitcnt lgkmcnt(4)
    s_nop 0
    v_mfma_f32_32x32x16_bf16 v[144:159], v[24:27], v[16:19], v[64:79]
    v_sub_f32 v80, 0, v238
    v_sub_f32 v81, 0, v238
    v_sub_f32 v82, 0, v238
    v_sub_f32 v83, 0, v238
    v_sub_f32 v84, 0, v238
    v_sub_f32 v85, 0, v238
    v_sub_f32 v86, 0, v238
    v_sub_f32 v87, 0, v238
    v_sub_f32 v88, 0, v238
    v_sub_f32 v89, 0, v238
    v_sub_f32 v90, 0, v238
    v_sub_f32 v91, 0, v238
    v_sub_f32 v92, 0, v238
    v_sub_f32 v93, 0, v238
    v_sub_f32 v94, 0, v238
    v_sub_f32 v95, 0, v238
    s_waitcnt lgkmcnt(0)
    s_mov_b32 s61, 33024
    s_mov_b32 s62, 4294901248
    s_mov_b32 s60, 0x42
    s_setprio 3
    v_exp_f32 v144, v144
    v_exp_f32 v145, v145
    v_smfmac_f32_32x32x32_bf16 v[192:207], v[44:47], v[168:175], v223
    ds_read_b128 v[28:31], v216 offset:4128
    ds_read_b128 v[40:43], v217 offset:4128
    ds_read_b128 v[44:47], v218 offset:4128
    v_exp_f32 v146, v146
    v_exp_f32 v147, v147
    v_exp_f32 v148, v148
    v_mfma_f32_32x32x16_bf16 v[160:175], v[24:27], v[20:23], v[80:95]
    v_exp_f32 v149, v149
    v_exp_f32 v150, v150
    v_exp_f32 v151, v151
    v_exp_f32 v152, v152
    v_exp_f32 v153, v153
    v_smfmac_f32_32x32x32_bf16 v[176:191], v[32:35], v[144:151], v223
    v_exp_f32 v154, v154
    v_exp_f32 v155, v155
    v_exp_f32 v156, v156
    v_exp_f32 v157, v157
    v_exp_f32 v158, v158
    v_exp_f32 v159, v159
    s_lshl_b32 s11, 1, s6
    v_add_u32 v1, 1, v232
    s_waitcnt vmcnt(0)
    s_mov_b32 exec_hi, 0
    s_mov_b32 exec_lo, s11
    buffer_store_dword v1, v233, s[48:51], s57 offen sc1
    s_mov_b64 exec, -1
    v_exp_f32 v160, v160
    v_exp_f32 v161, v161
    v_smfmac_f32_32x32x32_bf16 v[176:191], v[36:39], v[152:159], v223
    v_exp_f32 v162, v162
    v_exp_f32 v163, v163
    s_waitcnt lgkmcnt(0)
    v_exp_f32 v164, v164
    v_mfma_f32_32x32x16_bf16 v[144:159], v[28:31], v[16:19], v[64:79]
    v_exp_f32 v165, v165
    v_exp_f32 v166, v166
    v_exp_f32 v167, v167
    v_exp_f32 v168, v168
    v_exp_f32 v169, v169
    v_smfmac_f32_32x32x32_bf16 v[192:207], v[32:35], v[160:167], v223
    v_exp_f32 v170, v170
    v_exp_f32 v171, v171
    v_exp_f32 v172, v172
    v_exp_f32 v173, v173
    v_exp_f32 v174, v174
    v_exp_f32 v175, v175
    s_setprio 2
    v_exp_f32 v144, v144
    v_exp_f32 v145, v145
    v_smfmac_f32_32x32x32_bf16 v[192:207], v[36:39], v[168:175], v223
    ds_read_b128 v[24:27], v216 offset:8256
    ds_read_b128 v[32:35], v217 offset:8256
    ds_read_b128 v[36:39], v218 offset:8256
    v_exp_f32 v146, v146
    v_exp_f32 v147, v147
    v_exp_f32 v148, v148
    v_mfma_f32_32x32x16_bf16 v[160:175], v[28:31], v[20:23], v[80:95]
    v_exp_f32 v149, v149
    v_exp_f32 v150, v150
    v_exp_f32 v151, v151
    v_exp_f32 v152, v152
    v_exp_f32 v153, v153
    v_smfmac_f32_32x32x32_bf16 v[176:191], v[40:43], v[144:151], v223
    v_exp_f32 v154, v154
    v_exp_f32 v155, v155
    v_exp_f32 v156, v156
    v_exp_f32 v157, v157
    v_exp_f32 v158, v158
    v_exp_f32 v159, v159
    v_exp_f32 v160, v160
    v_exp_f32 v161, v161
    v_smfmac_f32_32x32x32_bf16 v[176:191], v[44:47], v[152:159], v223
    v_exp_f32 v162, v162
    v_exp_f32 v163, v163
    s_waitcnt lgkmcnt(0)
    v_exp_f32 v164, v164
    v_mfma_f32_32x32x16_bf16 v[144:159], v[24:27], v[16:19], v[64:79]
    v_exp_f32 v165, v165
    v_exp_f32 v166, v166
    v_exp_f32 v167, v167
    v_exp_f32 v168, v168
    v_exp_f32 v169, v169
    v_smfmac_f32_32x32x32_bf16 v[192:207], v[40:43], v[160:167], v223
    v_exp_f32 v170, v170
    v_exp_f32 v171, v171
    v_exp_f32 v172, v172
    v_exp_f32 v173, v173
    v_exp_f32 v174, v174
    v_exp_f32 v175, v175
    v_exp_f32 v144, v144
    v_exp_f32 v145, v145
    v_smfmac_f32_32x32x32_bf16 v[192:207], v[44:47], v[168:175], v223
    ds_read_b128 v[28:31], v216 offset:12384
    ds_read_b128 v[40:43], v217 offset:12384
    ds_read_b128 v[44:47], v218 offset:12384
    v_exp_f32 v146, v146
    v_exp_f32 v147, v147
    v_exp_f32 v148, v148
    v_mfma_f32_32x32x16_bf16 v[160:175], v[24:27], v[20:23], v[80:95]
    v_exp_f32 v149, v149
    v_exp_f32 v150, v150
    v_exp_f32 v151, v151
    v_exp_f32 v152, v152
    v_exp_f32 v153, v153
    v_smfmac_f32_32x32x32_bf16 v[176:191], v[32:35], v[144:151], v223
    v_exp_f32 v154, v154
    v_exp_f32 v155, v155
    v_exp_f32 v156, v156
    v_exp_f32 v157, v157
    v_exp_f32 v158, v158
    v_exp_f32 v159, v159
    buffer_load_dword v234, v233, s[48:51], s57 offen sc1
    v_exp_f32 v160, v160
    v_exp_f32 v161, v161
    v_smfmac_f32_32x32x32_bf16 v[176:191], v[36:39], v[152:159], v223
    v_exp_f32 v162, v162
    v_exp_f32 v163, v163
    s_waitcnt lgkmcnt(0)
    v_exp_f32 v164, v164
    v_mfma_f32_32x32x16_bf16 v[144:159], v[28:31], v[16:19], v[64:79]
    v_exp_f32 v165, v165
    v_exp_f32 v166, v166
    v_exp_f32 v167, v167
    v_exp_f32 v168, v168
    v_exp_f32 v169, v169
    v_smfmac_f32_32x32x32_bf16 v[192:207], v[32:35], v[160:167], v223
    v_exp_f32 v170, v170
    v_exp_f32 v171, v171
    v_exp_f32 v172, v172
    v_exp_f32 v173, v173
    v_exp_f32 v174, v174
    v_exp_f32 v175, v175
    s_setprio 1
    v_exp_f32 v144, v144
    v_exp_f32 v145, v145
    v_smfmac_f32_32x32x32_bf16 v[192:207], v[36:39], v[168:175], v223
    ds_read_b128 v[24:27], v216 offset:16512
    ds_read_b128 v[32:35], v217 offset:16512
    ds_read_b128 v[36:39], v218 offset:16512
    v_exp_f32 v146, v146
    v_exp_f32 v147, v147
    v_exp_f32 v148, v148
    v_mfma_f32_32x32x16_bf16 v[160:175], v[28:31], v[20:23], v[80:95]
    v_exp_f32 v149, v149
    v_exp_f32 v150, v150
    v_exp_f32 v151, v151
    v_exp_f32 v152, v152
    v_exp_f32 v153, v153
    v_smfmac_f32_32x32x32_bf16 v[176:191], v[40:43], v[144:151], v223
    v_exp_f32 v154, v154
    v_exp_f32 v155, v155
    v_exp_f32 v156, v156
    v_exp_f32 v157, v157
    v_exp_f32 v158, v158
    v_exp_f32 v159, v159
    s_waitcnt vmcnt(0)
    v_cmp_ne_u32 vcc, v234, v232
    s_nop 3
    s_or_b32 s68, s68, vcc_lo
    s_add_u32 s67, s6, s14
    s_add_u32 s67, s67, 1
    s_and_b32 s67, s67, 7
    s_bitcmp1_b32 s68, s67
    s_cbranch_scc0 F_pa_poll
F_pa_ok:
    s_lshl_b32 s67, s67, 15
    s_mov_b32 m0, s63
    s_add_u32 s67, s67, s13
    buffer_load_dwordx4 v4, s[48:51], s67 offen offset:0 sc1 lds
    buffer_load_dwordx4 v4, s[48:51], s67 offen offset:1024 sc1 lds
    buffer_load_dwordx4 v4, s[48:51], s67 offen offset:2048 sc1 lds
    buffer_load_dwordx4 v4, s[48:51], s67 offen offset:3072 sc1 lds
    v_exp_f32 v160, v160
    v_exp_f32 v161, v161
    v_smfmac_f32_32x32x32_bf16 v[176:191], v[44:47], v[152:159], v223
    v_exp_f32 v162, v162
    v_exp_f32 v163, v163
    s_waitcnt lgkmcnt(0)
    v_exp_f32 v164, v164
    v_mfma_f32_32x32x16_bf16 v[144:159], v[24:27], v[16:19], v[64:79]
    v_exp_f32 v165, v165
    v_exp_f32 v166, v166
    v_exp_f32 v167, v167
    v_exp_f32 v168, v168
    v_exp_f32 v169, v169
    v_smfmac_f32_32x32x32_bf16 v[192:207], v[40:43], v[160:167], v223
    v_exp_f32 v170, v170
    v_exp_f32 v171, v171
    v_exp_f32 v172, v172
    v_exp_f32 v173, v173
    v_exp_f32 v174, v174
    v_exp_f32 v175, v175
    v_exp_f32 v144, v144
    v_exp_f32 v145, v145
    v_smfmac_f32_32x32x32_bf16 v[192:207], v[44:47], v[168:175], v223
    ds_read_b128 v[28:31], v216 offset:20640
    ds_read_b128 v[40:43], v217 offset:20640
    ds_read_b128 v[44:47], v218 offset:20640
    v_exp_f32 v146, v146
    v_exp_f32 v147, v147
    v_exp_f32 v148, v148
    v_mfma_f32_32x32x16_bf16 v[160:175], v[24:27], v[20:23], v[80:95]
    v_exp_f32 v149, v149
    v_exp_f32 v150, v150
    v_exp_f32 v151, v151
    v_exp_f32 v152, v152
    v_exp_f32 v153, v153
    v_smfmac_f32_32x32x32_bf16 v[176:191], v[32:35], v[144:151], v223
    v_exp_f32 v154, v154
    v_exp_f32 v155, v155
    v_exp_f32 v156, v156
    v_exp_f32 v157, v157
    v_exp_f32 v158, v158
    v_exp_f32 v159, v159
    v_exp_f32 v160, v160
    v_exp_f32 v161, v161
    v_smfmac_f32_32x32x32_bf16 v[176:191], v[36:39], v[152:159], v223
    v_exp_f32 v162, v162
    v_exp_f32 v163, v163
    s_waitcnt lgkmcnt(0)
    v_exp_f32 v164, v164
    v_mfma_f32_32x32x16_bf16 v[144:159], v[28:31], v[16:19], v[64:79]
    v_exp_f32 v165, v165
    v_exp_f32 v166, v166
    v_exp_f32 v167, v167
    v_exp_f32 v168, v168
    v_exp_f32 v169, v169
    v_smfmac_f32_32x32x32_bf16 v[192:207], v[32:35], v[160:167], v223
    v_exp_f32 v170, v170
    v_exp_f32 v171, v171
    v_exp_f32 v172, v172
    v_exp_f32 v173, v173
    v_exp_f32 v174, v174
    v_exp_f32 v175, v175
    v_exp_f32 v144, v144
    v_exp_f32 v145, v145
    v_smfmac_f32_32x32x32_bf16 v[192:207], v[36:39], v[168:175], v223
    ds_read_b128 v[24:27], v216 offset:24768
    ds_read_b128 v[32:35], v217 offset:24768
    ds_read_b128 v[36:39], v218 offset:24768
    v_exp_f32 v146, v146
    v_exp_f32 v147, v147
    v_exp_f32 v148, v148
    v_mfma_f32_32x32x16_bf16 v[160:175], v[28:31], v[20:23], v[80:95]
    v_exp_f32 v149, v149
    v_exp_f32 v150, v150
    v_exp_f32 v151, v151
    v_exp_f32 v152, v152
    v_exp_f32 v153, v153
    v_smfmac_f32_32x32x32_bf16 v[176:191], v[40:43], v[144:151], v223
    v_exp_f32 v154, v154
    v_exp_f32 v155, v155
    v_exp_f32 v156, v156
    v_exp_f32 v157, v157
    v_exp_f32 v158, v158
    v_exp_f32 v159, v159
    s_setprio 0
    v_add_u32 v221, 1, v221
    s_waitcnt vmcnt(0)
    ds_write_b32 v219, v221
    v_exp_f32 v160, v160
    v_exp_f32 v161, v161
    v_smfmac_f32_32x32x32_bf16 v[176:191], v[44:47], v[152:159], v223
    v_exp_f32 v162, v162
    v_exp_f32 v163, v163
    s_waitcnt lgkmcnt(0)
    v_exp_f32 v164, v164
    v_mfma_f32_32x32x16_bf16 v[144:159], v[24:27], v[16:19], v[64:79]
    v_exp_f32 v165, v165
    v_exp_f32 v166, v166
    v_exp_f32 v167, v167
    v_exp_f32 v168, v168
    v_exp_f32 v169, v169
    v_smfmac_f32_32x32x32_bf16 v[192:207], v[40:43], v[160:167], v223
    v_exp_f32 v170, v170
    v_exp_f32 v171, v171
    v_exp_f32 v172, v172
    v_exp_f32 v173, v173
    v_exp_f32 v174, v174
    v_exp_f32 v175, v175
    v_exp_f32 v144, v144
    v_exp_f32 v145, v145
    v_smfmac_f32_32x32x32_bf16 v[192:207], v[44:47], v[168:175], v223
    ds_read_b128 v[28:31], v216 offset:28896
    ds_read_b128 v[40:43], v217 offset:28896
    ds_read_b128 v[44:47], v218 offset:28896
    v_exp_f32 v146, v146
    v_exp_f32 v147, v147
    v_exp_f32 v148, v148
    v_mfma_f32_32x32x16_bf16 v[160:175], v[24:27], v[20:23], v[80:95]
    v_exp_f32 v149, v149
    v_exp_f32 v150, v150
    v_exp_f32 v151, v151
    v_exp_f32 v152, v152
    v_exp_f32 v153, v153
    v_smfmac_f32_32x32x32_bf16 v[176:191], v[32:35], v[144:151], v223
    ds_read_b32 v222, v220
    v_exp_f32 v154, v154
    v_exp_f32 v155, v155
    v_exp_f32 v156, v156
    v_exp_f32 v157, v157
    v_exp_f32 v158, v158
    v_exp_f32 v159, v159
    v_exp_f32 v160, v160
    v_exp_f32 v161, v161
    v_smfmac_f32_32x32x32_bf16 v[176:191], v[36:39], v[152:159], v223
    v_exp_f32 v162, v162
    v_exp_f32 v163, v163
    s_waitcnt lgkmcnt(0)
    v_exp_f32 v164, v164
    v_mfma_f32_32x32x16_bf16 v[144:159], v[28:31], v[16:19], v[64:79]
    v_exp_f32 v165, v165
    v_exp_f32 v166, v166
    v_exp_f32 v167, v167
    v_exp_f32 v168, v168
    v_exp_f32 v169, v169
    v_smfmac_f32_32x32x32_bf16 v[192:207], v[32:35], v[160:167], v223
    v_exp_f32 v170, v170
    v_exp_f32 v171, v171
    v_exp_f32 v172, v172
    v_exp_f32 v173, v173
    v_exp_f32 v174, v174
    v_exp_f32 v175, v175
    v_cmp_gt_u32 vcc, v221, v222
    s_add_u32 s14, s14, 1
    s_cmp_lt_u32 s14, 7
    s_cbranch_vccnz F_wait_first
F_go_first:
.p2align 6
F_loop:
    s_setprio 3
    v_add_u32 v216, s15, v216
    v_add_u32 v217, s15, v217
    v_add_u32 v218, s15, v218
    v_exp_f32 v144, v144
    v_exp_f32 v145, v145
    v_smfmac_f32_32x32x32_bf16 v[192:207], v[36:39], v[168:175], v223
    ds_read_b128 v[24:27], v216 offset:0
    ds_read_b128 v[32:35], v217 offset:0
    ds_read_b128 v[36:39], v218 offset:0
    v_exp_f32 v146, v146
    v_exp_f32 v147, v147
    v_exp_f32 v148, v148
    v_mfma_f32_32x32x16_bf16 v[160:175], v[28:31], v[20:23], v[80:95]
    v_exp_f32 v149, v149
    v_exp_f32 v150, v150
    v_exp_f32 v151, v151
    v_exp_f32 v152, v152
    v_exp_f32 v153, v153
    v_smfmac_f32_32x32x32_bf16 v[176:191], v[40:43], v[144:151], v223
    v_exp_f32 v154, v154
    v_exp_f32 v155, v155
    v_exp_f32 v156, v156
    v_exp_f32 v157, v157
    v_exp_f32 v158, v158
    v_exp_f32 v159, v159
    s_add_u32 s63, s63, 33024
    s_sub_u32 s11, s63, 99072
    s_cmp_ge_u32 s63, 101120
    s_cselect_b32 s63, s11, s63
    s_cselect_b32 s15, s62, s61
    s_add_u32 s67, s6, s14
    s_add_u32 s67, s67, 1
    s_and_b32 s67, s67, 7
    s_bitcmp1_b32 s68, s67
    s_cbranch_scc0 F_pb_poll
F_pb_ok:
    s_lshl_b32 s67, s67, 15
    s_mov_b32 m0, s63
    s_add_u32 s67, s67, s13
    buffer_load_dwordx4 v4, s[48:51], s67 offen offset:0 sc1 lds
    buffer_load_dwordx4 v4, s[48:51], s67 offen offset:1024 sc1 lds
    buffer_load_dwordx4 v4, s[48:51], s67 offen offset:2048 sc1 lds
    buffer_load_dwordx4 v4, s[48:51], s67 offen offset:3072 sc1 lds
    s_bitcmp1_b32 s60, s14
    s_cbranch_scc1 F_special
F_spret:
    v_exp_f32 v160, v160
    v_exp_f32 v161, v161
    v_smfmac_f32_32x32x32_bf16 v[176:191], v[44:47], v[152:159], v223
    v_exp_f32 v162, v162
    v_exp_f32 v163, v163
    s_waitcnt lgkmcnt(0)
    v_exp_f32 v164, v164
    v_mfma_f32_32x32x16_bf16 v[144:159], v[24:27], v[16:19], v[64:79]
    v_exp_f32 v165, v165
    v_exp_f32 v166, v166
    v_exp_f32 v167, v167
    v_exp_f32 v168, v168
    v_exp_f32 v169, v169
    v_smfmac_f32_32x32x32_bf16 v[192:207], v[40:43], v[160:167], v223
    v_exp_f32 v170, v170
    v_exp_f32 v171, v171
    v_exp_f32 v172, v172
    v_exp_f32 v173, v173
    v_exp_f32 v174, v174
    v_exp_f32 v175, v175
    v_exp_f32 v144, v144
    v_exp_f32 v145, v145
    v_smfmac_f32_32x32x32_bf16 v[192:207], v[44:47], v[168:175], v223
    ds_read_b128 v[28:31], v216 offset:4128
    ds_read_b128 v[40:43], v217 offset:4128
    ds_read_b128 v[44:47], v218 offset:4128
    v_exp_f32 v146, v146
    v_exp_f32 v147, v147
    v_exp_f32 v148, v148
    v_mfma_f32_32x32x16_bf16 v[160:175], v[24:27], v[20:23], v[80:95]
    v_exp_f32 v149, v149
    v_exp_f32 v150, v150
    v_exp_f32 v151, v151
    v_exp_f32 v152, v152
    v_exp_f32 v153, v153
    v_smfmac_f32_32x32x32_bf16 v[176:191], v[32:35], v[144:151], v223
    v_exp_f32 v154, v154
    v_exp_f32 v155, v155
    v_exp_f32 v156, v156
    v_exp_f32 v157, v157
    v_exp_f32 v158, v158
    v_exp_f32 v159, v159
    v_exp_f32 v160, v160
    v_exp_f32 v161, v161
    v_smfmac_f32_32x32x32_bf16 v[176:191], v[36:39], v[152:159], v223
    v_exp_f32 v162, v162
    v_exp_f32 v163, v163
    s_waitcnt lgkmcnt(0)
    v_exp_f32 v164, v164
    v_mfma_f32_32x32x16_bf16 v[144:159], v[28:31], v[16:19], v[64:79]
    v_exp_f32 v165, v165
    v_exp_f32 v166, v166
    v_exp_f32 v167, v167
    v_exp_f32 v168, v168
    v_exp_f32 v169, v169
    v_smfmac_f32_32x32x32_bf16 v[192:207], v[32:35], v[160:167], v223
    v_exp_f32 v170, v170
    v_exp_f32 v171, v171
    v_exp_f32 v172, v172
    v_exp_f32 v173, v173
    v_exp_f32 v174, v174
    v_exp_f32 v175, v175
    v_exp_f32 v144, v144
    v_exp_f32 v145, v145
    v_smfmac_f32_32x32x32_bf16 v[192:207], v[36:39], v[168:175], v223
    ds_read_b128 v[24:27], v216 offset:8256
    ds_read_b128 v[32:35], v217 offset:8256
    ds_read_b128 v[36:39], v218 offset:8256
    v_exp_f32 v146, v146
    v_exp_f32 v147, v147
    v_exp_f32 v148, v148
    v_mfma_f32_32x32x16_bf16 v[160:175], v[28:31], v[20:23], v[80:95]
    v_exp_f32 v149, v149
    v_exp_f32 v150, v150
    v_exp_f32 v151, v151
    v_exp_f32 v152, v152
    v_exp_f32 v153, v153
    v_smfmac_f32_32x32x32_bf16 v[176:191], v[40:43], v[144:151], v223
    v_exp_f32 v154, v154
    v_exp_f32 v155, v155
    v_exp_f32 v156, v156
    v_exp_f32 v157, v157
    v_exp_f32 v158, v158
    v_exp_f32 v159, v159
    v_exp_f32 v160, v160
    v_exp_f32 v161, v161
    v_smfmac_f32_32x32x32_bf16 v[176:191], v[44:47], v[152:159], v223
    v_exp_f32 v162, v162
    v_exp_f32 v163, v163
    s_waitcnt lgkmcnt(0)
    v_exp_f32 v164, v164
    v_mfma_f32_32x32x16_bf16 v[144:159], v[24:27], v[16:19], v[64:79]
    v_exp_f32 v165, v165
    v_exp_f32 v166, v166
    v_exp_f32 v167, v167
    v_exp_f32 v168, v168
    v_exp_f32 v169, v169
    v_smfmac_f32_32x32x32_bf16 v[192:207], v[40:43], v[160:167], v223
    v_exp_f32 v170, v170
    v_exp_f32 v171, v171
    v_exp_f32 v172, v172
    v_exp_f32 v173, v173
    v_exp_f32 v174, v174
    v_exp_f32 v175, v175
    v_exp_f32 v144, v144
    v_exp_f32 v145, v145
    v_smfmac_f32_32x32x32_bf16 v[192:207], v[44:47], v[168:175], v223
    ds_read_b128 v[28:31], v216 offset:12384
    ds_read_b128 v[40:43], v217 offset:12384
    ds_read_b128 v[44:47], v218 offset:12384
    v_exp_f32 v146, v146
    v_exp_f32 v147, v147
    v_exp_f32 v148, v148
    v_mfma_f32_32x32x16_bf16 v[160:175], v[24:27], v[20:23], v[80:95]
    v_exp_f32 v149, v149
    v_exp_f32 v150, v150
    v_exp_f32 v151, v151
    v_exp_f32 v152, v152
    v_exp_f32 v153, v153
    v_smfmac_f32_32x32x32_bf16 v[176:191], v[32:35], v[144:151], v223
    v_exp_f32 v154, v154
    v_exp_f32 v155, v155
    v_exp_f32 v156, v156
    v_exp_f32 v157, v157
    v_exp_f32 v158, v158
    v_exp_f32 v159, v159
    v_exp_f32 v160, v160
    v_exp_f32 v161, v161
    v_smfmac_f32_32x32x32_bf16 v[176:191], v[36:39], v[152:159], v223
    v_exp_f32 v162, v162
    v_exp_f32 v163, v163
    s_waitcnt lgkmcnt(0)
    v_exp_f32 v164, v164
    v_mfma_f32_32x32x16_bf16 v[144:159], v[28:31], v[16:19], v[64:79]
    v_exp_f32 v165, v165
    v_exp_f32 v166, v166
    v_exp_f32 v167, v167
    v_exp_f32 v168, v168
    v_exp_f32 v169, v169
    v_smfmac_f32_32x32x32_bf16 v[192:207], v[32:35], v[160:167], v223
    v_exp_f32 v170, v170
    v_exp_f32 v171, v171
    v_exp_f32 v172, v172
    v_exp_f32 v173, v173
    v_exp_f32 v174, v174
    v_exp_f32 v175, v175
    s_setprio 2
    v_exp_f32 v144, v144
    v_exp_f32 v145, v145
    v_smfmac_f32_32x32x32_bf16 v[192:207], v[36:39], v[168:175], v223
    ds_read_b128 v[24:27], v216 offset:16512
    ds_read_b128 v[32:35], v217 offset:16512
    ds_read_b128 v[36:39], v218 offset:16512
    v_exp_f32 v146, v146
    v_exp_f32 v147, v147
    v_exp_f32 v148, v148
    v_mfma_f32_32x32x16_bf16 v[160:175], v[28:31], v[20:23], v[80:95]
    v_exp_f32 v149, v149
    v_exp_f32 v150, v150
    v_exp_f32 v151, v151
    v_exp_f32 v152, v152
    v_exp_f32 v153, v153
    v_smfmac_f32_32x32x32_bf16 v[176:191], v[40:43], v[144:151], v223
    v_exp_f32 v154, v154
    v_exp_f32 v155, v155
    v_exp_f32 v156, v156
    v_exp_f32 v157, v157
    v_exp_f32 v158, v158
    v_exp_f32 v159, v159
    v_exp_f32 v160, v160
    v_exp_f32 v161, v161
    v_smfmac_f32_32x32x32_bf16 v[176:191], v[44:47], v[152:159], v223
    v_exp_f32 v162, v162
    v_exp_f32 v163, v163
    s_waitcnt lgkmcnt(0)
    v_exp_f32 v164, v164
    v_mfma_f32_32x32x16_bf16 v[144:159], v[24:27], v[16:19], v[64:79]
    v_exp_f32 v165, v165
    v_exp_f32 v166, v166
    v_exp_f32 v167, v167
    v_exp_f32 v168, v168
    v_exp_f32 v169, v169
    v_smfmac_f32_32x32x32_bf16 v[192:207], v[40:43], v[160:167], v223
    v_exp_f32 v170, v170
    v_exp_f32 v171, v171
    v_exp_f32 v172, v172
    v_exp_f32 v173, v173
    v_exp_f32 v174, v174
    v_exp_f32 v175, v175
    v_exp_f32 v144, v144
    v_exp_f32 v145, v145
    v_smfmac_f32_32x32x32_bf16 v[192:207], v[44:47], v[168:175], v223
    ds_read_b128 v[28:31], v216 offset:20640
    ds_read_b128 v[40:43], v217 offset:20640
    ds_read_b128 v[44:47], v218 offset:20640
    v_exp_f32 v146, v146
    v_exp_f32 v147, v147
    v_exp_f32 v148, v148
    v_mfma_f32_32x32x16_bf16 v[160:175], v[24:27], v[20:23], v[80:95]
    v_exp_f32 v149, v149
    v_exp_f32 v150, v150
    v_exp_f32 v151, v151
    v_exp_f32 v152, v152
    v_exp_f32 v153, v153
    v_smfmac_f32_32x32x32_bf16 v[176:191], v[32:35], v[144:151], v223
    v_exp_f32 v154, v154
    v_exp_f32 v155, v155
    v_exp_f32 v156, v156
    v_exp_f32 v157, v157
    v_exp_f32 v158, v158
    v_exp_f32 v159, v159
    v_exp_f32 v160, v160
    v_exp_f32 v161, v161
    v_smfmac_f32_32x32x32_bf16 v[176:191], v[36:39], v[152:159], v223
    v_exp_f32 v162, v162
    v_exp_f32 v163, v163
    s_waitcnt lgkmcnt(0)
    v_exp_f32 v164, v164
    v_mfma_f32_32x32x16_bf16 v[144:159], v[28:31], v[16:19], v[64:79]
    v_exp_f32 v165, v165
    v_exp_f32 v166, v166
    v_exp_f32 v167, v167
    v_exp_f32 v168, v168
    v_exp_f32 v169, v169
    v_smfmac_f32_32x32x32_bf16 v[192:207], v[32:35], v[160:167], v223
    v_exp_f32 v170, v170
    v_exp_f32 v171, v171
    v_exp_f32 v172, v172
    v_exp_f32 v173, v173
    v_exp_f32 v174, v174
    v_exp_f32 v175, v175
    s_setprio 1
    v_exp_f32 v144, v144
    v_exp_f32 v145, v145
    v_smfmac_f32_32x32x32_bf16 v[192:207], v[36:39], v[168:175], v223
    ds_read_b128 v[24:27], v216 offset:24768
    ds_read_b128 v[32:35], v217 offset:24768
    ds_read_b128 v[36:39], v218 offset:24768
    v_exp_f32 v146, v146
    v_exp_f32 v147, v147
    v_exp_f32 v148, v148
    v_mfma_f32_32x32x16_bf16 v[160:175], v[28:31], v[20:23], v[80:95]
    v_exp_f32 v149, v149
    v_exp_f32 v150, v150
    v_exp_f32 v151, v151
    v_exp_f32 v152, v152
    v_exp_f32 v153, v153
    v_smfmac_f32_32x32x32_bf16 v[176:191], v[40:43], v[144:151], v223
    v_exp_f32 v154, v154
    v_exp_f32 v155, v155
    v_exp_f32 v156, v156
    v_exp_f32 v157, v157
    v_exp_f32 v158, v158
    v_exp_f32 v159, v159
    v_add_u32 v221, 1, v221
    s_waitcnt vmcnt(0)
    ds_write_b32 v219, v221
    v_exp_f32 v160, v160
    v_exp_f32 v161, v161
    v_smfmac_f32_32x32x32_bf16 v[176:191], v[44:47], v[152:159], v223
    v_exp_f32 v162, v162
    v_exp_f32 v163, v163
    s_waitcnt lgkmcnt(0)
    v_exp_f32 v164, v164
    v_mfma_f32_32x32x16_bf16 v[144:159], v[24:27], v[16:19], v[64:79]
    v_exp_f32 v165, v165
    v_exp_f32 v166, v166
    v_exp_f32 v167, v167
    v_exp_f32 v168, v168
    v_exp_f32 v169, v169
    v_smfmac_f32_32x32x32_bf16 v[192:207], v[40:43], v[160:167], v223
    v_exp_f32 v170, v170
    v_exp_f32 v171, v171
    v_exp_f32 v172, v172
    v_exp_f32 v173, v173
    v_exp_f32 v174, v174
    v_exp_f32 v175, v175
    s_setprio 0
    v_exp_f32 v144, v144
    v_exp_f32 v145, v145
    v_smfmac_f32_32x32x32_bf16 v[192:207], v[44:47], v[168:175], v223
    ds_read_b128 v[28:31], v216 offset:28896
    ds_read_b128 v[40:43], v217 offset:28896
    ds_read_b128 v[44:47], v218 offset:28896
    v_exp_f32 v146, v146
    v_exp_f32 v147, v147
    v_exp_f32 v148, v148
    v_mfma_f32_32x32x16_bf16 v[160:175], v[24:27], v[20:23], v[80:95]
    v_exp_f32 v149, v149
    v_exp_f32 v150, v150
    v_exp_f32 v151, v151
    v_exp_f32 v152, v152
    v_exp_f32 v153, v153
    v_smfmac_f32_32x32x32_bf16 v[176:191], v[32:35], v[144:151], v223
    ds_read_b32 v222, v220
    v_exp_f32 v154, v154
    v_exp_f32 v155, v155
    v_exp_f32 v156, v156
    v_exp_f32 v157, v157
    v_exp_f32 v158, v158
    v_exp_f32 v159, v159
    v_exp_f32 v160, v160
    v_exp_f32 v161, v161
    v_smfmac_f32_32x32x32_bf16 v[176:191], v[36:39], v[152:159], v223
    v_exp_f32 v162, v162
    v_exp_f32 v163, v163
    s_waitcnt lgkmcnt(0)
    v_exp_f32 v164, v164
    v_mfma_f32_32x32x16_bf16 v[144:159], v[28:31], v[16:19], v[64:79]
    v_exp_f32 v165, v165
    v_exp_f32 v166, v166
    v_exp_f32 v167, v167
    v_exp_f32 v168, v168
    v_exp_f32 v169, v169
    v_smfmac_f32_32x32x32_bf16 v[192:207], v[32:35], v[160:167], v223
    v_exp_f32 v170, v170
    v_exp_f32 v171, v171
    v_exp_f32 v172, v172
    v_exp_f32 v173, v173
    v_exp_f32 v174, v174
    v_exp_f32 v175, v175
    v_cmp_gt_u32 vcc, v221, v222
    s_add_u32 s14, s14, 1
    s_cmp_lt_u32 s14, 7
    s_cbranch_vccnz F_wait_mid
F_go_mid:
    s_cbranch_scc1 F_loop
    s_setprio 3
    v_add_u32 v216, s15, v216
    v_add_u32 v217, s15, v217
    v_add_u32 v218, s15, v218
    v_exp_f32 v144, v144
    v_exp_f32 v145, v145
    v_smfmac_f32_32x32x32_bf16 v[192:207], v[36:39], v[168:175], v223
    ds_read_b128 v[24:27], v216 offset:0
    ds_read_b128 v[32:35], v217 offset:0
    ds_read_b128 v[36:39], v218 offset:0
    v_exp_f32 v146, v146
    v_exp_f32 v147, v147
    v_exp_f32 v148, v148
    v_mfma_f32_32x32x16_bf16 v[160:175], v[28:31], v[20:23], v[80:95]
    v_exp_f32 v149, v149
    v_exp_f32 v150, v150
    v_exp_f32 v151, v151
    v_exp_f32 v152, v152
    v_exp_f32 v153, v153
    v_smfmac_f32_32x32x32_bf16 v[176:191], v[40:43], v[144:151], v223
    v_exp_f32 v154, v154
    v_exp_f32 v155, v155
    v_exp_f32 v156, v156
    v_exp_f32 v157, v157
    v_exp_f32 v158, v158
    v_exp_f32 v159, v159
    v_cmp_eq_u32 vcc, 0, v240
    s_cmp_eq_u32 s4, 0
    s_cselect_b32 s40, s20, s26
    s_cselect_b32 s41, s21, s27
    s_mov_b32 s42, 524288
    s_cbranch_vccnz F_notstarted
F_started:
    s_lshl_b32 s64, s10, 16
    s_and_b32 s11, s5, 7
    s_lshl_b32 s65, s11, 7
    s_add_u32 s64, s64, s65
    s_lshl_b32 s54, s10, 13
    v_exp_f32 v160, v160
    v_exp_f32 v161, v161
    v_smfmac_f32_32x32x32_bf16 v[176:191], v[44:47], v[152:159], v223
    v_exp_f32 v162, v162
    v_exp_f32 v163, v163
    s_waitcnt lgkmcnt(0)
    v_exp_f32 v164, v164
    v_mfma_f32_32x32x16_bf16 v[144:159], v[24:27], v[16:19], v[64:79]
    v_exp_f32 v165, v165
    v_exp_f32 v166, v166
    v_exp_f32 v167, v167
    v_exp_f32 v168, v168
    v_exp_f32 v169, v169
    v_smfmac_f32_32x32x32_bf16 v[192:207], v[40:43], v[160:167], v223
    v_exp_f32 v170, v170
    v_exp_f32 v171, v171
    v_exp_f32 v172, v172
    v_exp_f32 v173, v173
    v_exp_f32 v174, v174
    v_exp_f32 v175, v175
    s_add_u32 m0, s54, 98304
    s_add_u32 s11, s64, 0
    buffer_load_dwordx4 v246, s[40:43], s11 offen lds
    s_add_u32 m0, s54, 99328
    s_add_u32 s11, s64, 8192
    buffer_load_dwordx4 v246, s[40:43], s11 offen lds
    v_exp_f32 v144, v144
    v_exp_f32 v145, v145
    v_smfmac_f32_32x32x32_bf16 v[192:207], v[44:47], v[168:175], v223
    ds_read_b128 v[28:31], v216 offset:4128
    ds_read_b128 v[40:43], v217 offset:4128
    ds_read_b128 v[44:47], v218 offset:4128
    v_exp_f32 v146, v146
    v_exp_f32 v147, v147
    v_exp_f32 v148, v148
    v_mfma_f32_32x32x16_bf16 v[160:175], v[24:27], v[20:23], v[80:95]
    v_exp_f32 v149, v149
    v_exp_f32 v150, v150
    v_exp_f32 v151, v151
    v_exp_f32 v152, v152
    v_exp_f32 v153, v153
    v_smfmac_f32_32x32x32_bf16 v[176:191], v[32:35], v[144:151], v223
    v_exp_f32 v154, v154
    v_exp_f32 v155, v155
    v_exp_f32 v156, v156
    v_exp_f32 v157, v157
    v_exp_f32 v158, v158
    v_exp_f32 v159, v159
    s_add_u32 m0, s54, 100352
    s_add_u32 s11, s64, 16384
    buffer_load_dwordx4 v246, s[40:43], s11 offen lds
    s_add_u32 m0, s54, 101376
    s_add_u32 s11, s64, 24576
    buffer_load_dwordx4 v246, s[40:43], s11 offen lds
    v_exp_f32 v160, v160
    v_exp_f32 v161, v161
    v_smfmac_f32_32x32x32_bf16 v[176:191], v[36:39], v[152:159], v223
    v_exp_f32 v162, v162
    v_exp_f32 v163, v163
    s_waitcnt lgkmcnt(0)
    v_exp_f32 v164, v164
    v_mfma_f32_32x32x16_bf16 v[144:159], v[28:31], v[16:19], v[64:79]
    v_exp_f32 v165, v165
    v_exp_f32 v166, v166
    v_exp_f32 v167, v167
    v_exp_f32 v168, v168
    v_exp_f32 v169, v169
    v_smfmac_f32_32x32x32_bf16 v[192:207], v[32:35], v[160:167], v223
    v_exp_f32 v170, v170
    v_exp_f32 v171, v171
    v_exp_f32 v172, v172
    v_exp_f32 v173, v173
    v_exp_f32 v174, v174
    v_exp_f32 v175, v175
    s_add_u32 m0, s54, 102400
    s_add_u32 s11, s64, 32768
    buffer_load_dwordx4 v246, s[40:43], s11 offen lds
    s_add_u32 m0, s54, 103424
    s_add_u32 s11, s64, 40960
    buffer_load_dwordx4 v246, s[40:43], s11 offen lds
    v_exp_f32 v144, v144
    v_exp_f32 v145, v145
    v_smfmac_f32_32x32x32_bf16 v[192:207], v[36:39], v[168:175], v223
    ds_read_b128 v[24:27], v216 offset:8256
    ds_read_b128 v[32:35], v217 offset:8256
    ds_read_b128 v[36:39], v218 offset:8256
    v_exp_f32 v146, v146
    v_exp_f32 v147, v147
    v_exp_f32 v148, v148
    v_mfma_f32_32x32x16_bf16 v[160:175], v[28:31], v[20:23], v[80:95]
    v_exp_f32 v149, v149
    v_exp_f32 v150, v150
    v_exp_f32 v151, v151
    v_exp_f32 v152, v152
    v_exp_f32 v153, v153
    v_smfmac_f32_32x32x32_bf16 v[176:191], v[40:43], v[144:151], v223
    v_exp_f32 v154, v154
    v_exp_f32 v155, v155
    v_exp_f32 v156, v156
    v_exp_f32 v157, v157
    v_exp_f32 v158, v158
    v_exp_f32 v159, v159
    s_add_u32 m0, s54, 104448
    s_add_u32 s11, s64, 49152
    buffer_load_dwordx4 v246, s[40:43], s11 offen lds
    s_add_u32 m0, s54, 105472
    s_add_u32 s11, s64, 57344
    buffer_load_dwordx4 v246, s[40:43], s11 offen lds
    v_exp_f32 v160, v160
    v_exp_f32 v161, v161
    v_smfmac_f32_32x32x32_bf16 v[176:191], v[44:47], v[152:159], v223
    v_exp_f32 v162, v162
    v_exp_f32 v163, v163
    s_waitcnt lgkmcnt(0)
    v_exp_f32 v164, v164
    v_mfma_f32_32x32x16_bf16 v[144:159], v[24:27], v[16:19], v[64:79]
    v_exp_f32 v165, v165
    v_exp_f32 v166, v166
    v_exp_f32 v167, v167
    v_exp_f32 v168, v168
    v_exp_f32 v169, v169
    v_smfmac_f32_32x32x32_bf16 v[192:207], v[40:43], v[160:167], v223
    v_exp_f32 v170, v170
    v_exp_f32 v171, v171
    v_exp_f32 v172, v172
    v_exp_f32 v173, v173
    v_exp_f32 v174, v174
    v_exp_f32 v175, v175
    v_exp_f32 v144, v144
    v_exp_f32 v145, v145
    v_smfmac_f32_32x32x32_bf16 v[192:207], v[44:47], v[168:175], v223
    ds_read_b128 v[28:31], v216 offset:12384
    ds_read_b128 v[40:43], v217 offset:12384
    ds_read_b128 v[44:47], v218 offset:12384
    v_exp_f32 v146, v146
    v_exp_f32 v147, v147
    v_exp_f32 v148, v148
    v_mfma_f32_32x32x16_bf16 v[160:175], v[24:27], v[20:23], v[80:95]
    v_exp_f32 v149, v149
    v_exp_f32 v150, v150
    v_exp_f32 v151, v151
    v_exp_f32 v152, v152
    v_exp_f32 v153, v153
    v_smfmac_f32_32x32x32_bf16 v[176:191], v[32:35], v[144:151], v223
    v_exp_f32 v154, v154
    v_exp_f32 v155, v155
    v_exp_f32 v156, v156
    v_exp_f32 v157, v157
    v_exp_f32 v158, v158
    v_exp_f32 v159, v159
    v_exp_f32 v160, v160
    v_exp_f32 v161, v161
    v_smfmac_f32_32x32x32_bf16 v[176:191], v[36:39], v[152:159], v223
    v_exp_f32 v162, v162
    v_exp_f32 v163, v163
    s_waitcnt lgkmcnt(0)
    v_exp_f32 v164, v164
    v_mfma_f32_32x32x16_bf16 v[144:159], v[28:31], v[16:19], v[64:79]
    v_exp_f32 v165, v165
    v_exp_f32 v166, v166
    v_exp_f32 v167, v167
    v_exp_f32 v168, v168
    v_exp_f32 v169, v169
    v_smfmac_f32_32x32x32_bf16 v[192:207], v[32:35], v[160:167], v223
    v_exp_f32 v170, v170
    v_exp_f32 v171, v171
    v_exp_f32 v172, v172
    v_exp_f32 v173, v173
    v_exp_f32 v174, v174
    v_exp_f32 v175, v175
    s_setprio 2
    v_exp_f32 v144, v144
    v_exp_f32 v145, v145
    v_smfmac_f32_32x32x32_bf16 v[192:207], v[36:39], v[168:175], v223
    ds_read_b128 v[24:27], v216 offset:16512
    ds_read_b128 v[32:35], v217 offset:16512
    ds_read_b128 v[36:39], v218 offset:16512
    v_exp_f32 v146, v146
    v_exp_f32 v147, v147
    v_exp_f32 v148, v148
    v_mfma_f32_32x32x16_bf16 v[160:175], v[28:31], v[20:23], v[80:95]
    v_exp_f32 v149, v149
    v_exp_f32 v150, v150
    v_exp_f32 v151, v151
    v_exp_f32 v152, v152
    v_exp_f32 v153, v153
    v_smfmac_f32_32x32x32_bf16 v[176:191], v[40:43], v[144:151], v223
    v_exp_f32 v154, v154
    v_exp_f32 v155, v155
    v_exp_f32 v156, v156
    v_exp_f32 v157, v157
    v_exp_f32 v158, v158
    v_exp_f32 v159, v159
    v_exp_f32 v160, v160
    v_exp_f32 v161, v161
    v_smfmac_f32_32x32x32_bf16 v[176:191], v[44:47], v[152:159], v223
    v_exp_f32 v162, v162
    v_exp_f32 v163, v163
    s_waitcnt lgkmcnt(0)
    v_exp_f32 v164, v164
    v_mfma_f32_32x32x16_bf16 v[144:159], v[24:27], v[16:19], v[64:79]
    v_exp_f32 v165, v165
    v_exp_f32 v166, v166
    v_exp_f32 v167, v167
    v_exp_f32 v168, v168
    v_exp_f32 v169, v169
    v_smfmac_f32_32x32x32_bf16 v[192:207], v[40:43], v[160:167], v223
    v_exp_f32 v170, v170
    v_exp_f32 v171, v171
    v_exp_f32 v172, v172
    v_exp_f32 v173, v173
    v_exp_f32 v174, v174
    v_exp_f32 v175, v175
    v_exp_f32 v144, v144
    v_exp_f32 v145, v145
    v_smfmac_f32_32x32x32_bf16 v[192:207], v[44:47], v[168:175], v223
    ds_read_b128 v[28:31], v216 offset:20640
    ds_read_b128 v[40:43], v217 offset:20640
    ds_read_b128 v[44:47], v218 offset:20640
    v_exp_f32 v146, v146
    v_exp_f32 v147, v147
    v_exp_f32 v148, v148
    v_mfma_f32_32x32x16_bf16 v[160:175], v[24:27], v[20:23], v[80:95]
    v_exp_f32 v149, v149
    v_exp_f32 v150, v150
    v_exp_f32 v151, v151
    v_exp_f32 v152, v152
    v_exp_f32 v153, v153
    v_smfmac_f32_32x32x32_bf16 v[176:191], v[32:35], v[144:151], v223
    v_exp_f32 v154, v154
    v_exp_f32 v155, v155
    v_exp_f32 v156, v156
    v_exp_f32 v157, v157
    v_exp_f32 v158, v158
    v_exp_f32 v159, v159
    v_exp_f32 v160, v160
    v_exp_f32 v161, v161
    v_smfmac_f32_32x32x32_bf16 v[176:191], v[36:39], v[152:159], v223
    v_exp_f32 v162, v162
    v_exp_f32 v163, v163
    s_waitcnt lgkmcnt(0)
    v_exp_f32 v164, v164
    v_mfma_f32_32x32x16_bf16 v[144:159], v[28:31], v[16:19], v[64:79]
    v_exp_f32 v165, v165
    v_exp_f32 v166, v166
    v_exp_f32 v167, v167
    v_exp_f32 v168, v168
    v_exp_f32 v169, v169
    v_smfmac_f32_32x32x32_bf16 v[192:207], v[32:35], v[160:167], v223
    v_exp_f32 v170, v170
    v_exp_f32 v171, v171
    v_exp_f32 v172, v172
    v_exp_f32 v173, v173
    v_exp_f32 v174, v174
    v_exp_f32 v175, v175
    s_setprio 1
    v_exp_f32 v144, v144
    v_exp_f32 v145, v145
    v_smfmac_f32_32x32x32_bf16 v[192:207], v[36:39], v[168:175], v223
    ds_read_b128 v[24:27], v216 offset:24768
    ds_read_b128 v[32:35], v217 offset:24768
    ds_read_b128 v[36:39], v218 offset:24768
    v_exp_f32 v146, v146
    v_exp_f32 v147, v147
    v_exp_f32 v148, v148
    v_mfma_f32_32x32x16_bf16 v[160:175], v[28:31], v[20:23], v[80:95]
    v_exp_f32 v149, v149
    v_exp_f32 v150, v150
    v_exp_f32 v151, v151
    v_exp_f32 v152, v152
    v_exp_f32 v153, v153
    v_smfmac_f32_32x32x32_bf16 v[176:191], v[40:43], v[144:151], v223
    v_exp_f32 v154, v154
    v_exp_f32 v155, v155
    v_exp_f32 v156, v156
    v_exp_f32 v157, v157
    v_exp_f32 v158, v158
    v_exp_f32 v159, v159
    v_add_u32 v221, 1, v221
    s_waitcnt vmcnt(0)
    ds_write_b32 v219, v221
    v_exp_f32 v160, v160
    v_exp_f32 v161, v161
    v_smfmac_f32_32x32x32_bf16 v[176:191], v[44:47], v[152:159], v223
    v_exp_f32 v162, v162
    v_exp_f32 v163, v163
    s_waitcnt lgkmcnt(0)
    v_exp_f32 v164, v164
    v_mfma_f32_32x32x16_bf16 v[144:159], v[24:27], v[16:19], v[64:79]
    v_exp_f32 v165, v165
    v_exp_f32 v166, v166
    v_exp_f32 v167, v167
    v_exp_f32 v168, v168
    v_exp_f32 v169, v169
    v_smfmac_f32_32x32x32_bf16 v[192:207], v[40:43], v[160:167], v223
    v_exp_f32 v170, v170
    v_exp_f32 v171, v171
    v_exp_f32 v172, v172
    v_exp_f32 v173, v173
    v_exp_f32 v174, v174
    v_exp_f32 v175, v175
    s_setprio 0
    v_exp_f32 v144, v144
    v_exp_f32 v145, v145
    v_smfmac_f32_32x32x32_bf16 v[192:207], v[44:47], v[168:175], v223
    ds_read_b128 v[28:31], v216 offset:28896
    ds_read_b128 v[40:43], v217 offset:28896
    ds_read_b128 v[44:47], v218 offset:28896
    v_exp_f32 v146, v146
    v_exp_f32 v147, v147
    v_exp_f32 v148, v148
    v_mfma_f32_32x32x16_bf16 v[160:175], v[24:27], v[20:23], v[80:95]
    v_exp_f32 v149, v149
    v_exp_f32 v150, v150
    v_exp_f32 v151, v151
    v_exp_f32 v152, v152
    v_exp_f32 v153, v153
    v_smfmac_f32_32x32x32_bf16 v[176:191], v[32:35], v[144:151], v223
    ds_read_b32 v222, v220
    v_exp_f32 v154, v154
    v_exp_f32 v155, v155
    v_exp_f32 v156, v156
    v_exp_f32 v157, v157
    v_exp_f32 v158, v158
    v_exp_f32 v159, v159
    v_exp_f32 v160, v160
    v_exp_f32 v161, v161
    v_smfmac_f32_32x32x32_bf16 v[176:191], v[36:39], v[152:159], v223
    v_exp_f32 v162, v162
    v_exp_f32 v163, v163
    s_waitcnt lgkmcnt(0)
    v_exp_f32 v164, v164
    v_mfma_f32_32x32x16_bf16 v[144:159], v[28:31], v[16:19], v[64:79]
    v_exp_f32 v165, v165
    v_exp_f32 v166, v166
    v_exp_f32 v167, v167
    v_exp_f32 v168, v168
    v_exp_f32 v169, v169
    v_smfmac_f32_32x32x32_bf16 v[192:207], v[32:35], v[160:167], v223
    v_exp_f32 v170, v170
    v_exp_f32 v171, v171
    v_exp_f32 v172, v172
    v_exp_f32 v173, v173
    v_exp_f32 v174, v174
    v_exp_f32 v175, v175
    v_cmp_gt_u32 vcc, v221, v222
    s_add_u32 s14, s14, 1
    s_cmp_lt_u32 s14, 7
    s_cbranch_vccnz F_wait_last
F_go_last:
    v_exp_f32 v144, v144
    v_exp_f32 v145, v145
    v_smfmac_f32_32x32x32_bf16 v[192:207], v[36:39], v[168:175], v223
    v_exp_f32 v146, v146
    v_exp_f32 v147, v147
    v_exp_f32 v148, v148
    v_mfma_f32_32x32x16_bf16 v[160:175], v[28:31], v[20:23], v[80:95]
    v_exp_f32 v149, v149
    v_exp_f32 v150, v150
    v_exp_f32 v151, v151
    v_exp_f32 v152, v152
    v_exp_f32 v153, v153
    v_smfmac_f32_32x32x32_bf16 v[176:191], v[40:43], v[144:151], v223
    v_exp_f32 v154, v154
    v_exp_f32 v155, v155
    v_exp_f32 v156, v156
    v_exp_f32 v157, v157
    v_exp_f32 v158, v158
    v_exp_f32 v159, v159
    v_exp_f32 v160, v160
    v_exp_f32 v161, v161
    v_smfmac_f32_32x32x32_bf16 v[176:191], v[44:47], v[152:159], v223
    v_exp_f32 v162, v162
    v_exp_f32 v163, v163
    v_exp_f32 v164, v164
    v_exp_f32 v165, v165
    v_exp_f32 v166, v166
    v_exp_f32 v167, v167
    v_exp_f32 v168, v168
    v_exp_f32 v169, v169
    v_smfmac_f32_32x32x32_bf16 v[192:207], v[40:43], v[160:167], v223
    v_exp_f32 v170, v170
    v_exp_f32 v171, v171
    v_exp_f32 v172, v172
    v_exp_f32 v173, v173
    v_exp_f32 v174, v174
    v_exp_f32 v175, v175
    s_nop 1
    v_smfmac_f32_32x32x32_bf16 v[192:207], v[44:47], v[168:175], v223
    s_lshl_b32 s56, s3, 1
    s_lshr_b32 s12, s5, 3
    s_add_u32 s56, s56, s12
    s_lshl_b32 s56, s56, 3
    s_add_u32 s56, s56, s10
    s_lshr_b32 s61, s56, 1
    s_lshl_b32 s61, s61, 15
    s_and_b32 s12, s10, 1
    s_lshl_b32 s12, s12, 8
    s_add_u32 s61, s61, s12
    s_add_u32 s61, s61, 8388608
    s_mov_b32 s60, 0x67800000
    v_cmp_nge_f32 vcc, s60, v184
    v_cmp_nge_f32 s[62:63], s60, v200
    v_rcp_f32 v237, v184
    v_rcp_f32 v238, v200
    s_nop 1
    s_or_b64 vcc, vcc, s[62:63]
    s_cbranch_scc1 F_slow
F_fin:
    v_mul_f32 v176, v176, v237
    v_mul_f32 v177, v177, v237
    v_mul_f32 v178, v178, v237
    v_mul_f32 v179, v179, v237
    v_mul_f32 v180, v180, v237
    v_mul_f32 v181, v181, v237
    v_mul_f32 v182, v182, v237
    v_mul_f32 v183, v183, v237
    v_cvt_pk_bf16_f32 v8, v176, v177
    v_cvt_pk_bf16_f32 v9, v178, v179
    v_cvt_pk_bf16_f32 v10, v180, v181
    v_cvt_pk_bf16_f32 v11, v182, v183
    v_min_u32 v8, -2, v8
    v_min_u32 v9, -2, v9
    v_min_u32 v10, -2, v10
    v_min_u32 v11, -2, v11
    buffer_store_dwordx4 v[8:11], v4, s[48:51], s52 offen sc1
    v_mul_f32 v192, v192, v238
    v_mul_f32 v193, v193, v238
    v_mul_f32 v194, v194, v238
    v_mul_f32 v195, v195, v238
    v_mul_f32 v196, v196, v238
    v_mul_f32 v197, v197, v238
    v_mul_f32 v198, v198, v238
    v_mul_f32 v199, v199, v238
    v_cvt_pk_bf16_f32 v12, v192, v193
    v_cvt_pk_bf16_f32 v13, v194, v195
    v_cvt_pk_bf16_f32 v14, v196, v197
    v_cvt_pk_bf16_f32 v15, v198, v199
    v_min_u32 v12, -2, v12
    v_min_u32 v13, -2, v13
    v_min_u32 v14, -2, v14
    v_min_u32 v15, -2, v15
    buffer_store_dwordx4 v[12:15], v4, s[48:51], s53 offen sc1
    s_cmp_lg_u32 s10, 7
    s_cbranch_scc1 T_nh
    s_lshl_b32 s11, 1, s5
    v_add_u32 v1, 1, v235
    s_mov_b32 exec_hi, 0
    s_mov_b32 exec_lo, s11
    buffer_store_dword v1, v236, s[48:51], s7 offen sc1
    s_mov_b64 exec, -1
T_nh:
    s_and_b32 s9, s5, 3
    s_xor_b32 s11, s9, 0
    s_lshl_b32 s12, s11, 14
    s_add_u32 s12, s12, 98304
    s_lshl_b32 s64, s11, 13
    s_add_u32 s64, s64, s61
    v_add_u32 v216, s12, v241
    v_xor_b32 v217, 32, v216
    v_xor_b32 v218, 64, v216
    v_xor_b32 v219, 0x60, v216
    s_xor_b32 s11, s9, 1
    s_lshl_b32 s12, s11, 14
    s_add_u32 s12, s12, 98304
    s_lshl_b32 s65, s11, 13
    s_add_u32 s65, s65, s61
    v_add_u32 v220, s12, v241
    v_xor_b32 v221, 32, v220
    v_xor_b32 v222, 64, v220
    v_xor_b32 v223, 0x60, v220
    s_xor_b32 s11, s9, 2
    s_lshl_b32 s12, s11, 14
    s_add_u32 s12, s12, 98304
    s_lshl_b32 s66, s11, 13
    s_add_u32 s66, s66, s61
    v_add_u32 v224, s12, v241
    v_xor_b32 v225, 32, v224
    v_xor_b32 v226, 64, v224
    v_xor_b32 v227, 0x60, v224
    s_xor_b32 s11, s9, 3
    s_lshl_b32 s12, s11, 14
    s_add_u32 s12, s12, 98304
    s_lshl_b32 s67, s11, 13
    s_add_u32 s67, s67, s61
    v_add_u32 v228, s12, v241
    v_xor_b32 v229, 32, v228
    v_xor_b32 v231, 64, v228
    v_xor_b32 v247, 0x60, v228
    s_cmp_lg_u32 s10, 1
    s_cbranch_scc1 T_np
    buffer_load_dword v234, v236, s[48:51], s7 offen sc1
T_np:
    ds_read_b64_tr_b16 v[96:97], v216 offset:0
    ds_read_b64_tr_b16 v[98:99], v216 offset:1024
    ds_read_b64_tr_b16 v[100:101], v217 offset:0
    ds_read_b64_tr_b16 v[102:103], v217 offset:1024
    ds_read_b64_tr_b16 v[104:105], v218 offset:0
    ds_read_b64_tr_b16 v[106:107], v218 offset:1024
    ds_read_b64_tr_b16 v[108:109], v219 offset:0
    ds_read_b64_tr_b16 v[110:111], v219 offset:1024
    ds_read_b64_tr_b16 v[112:113], v216 offset:4096
    ds_read_b64_tr_b16 v[114:115], v216 offset:5120
    ds_read_b64_tr_b16 v[116:117], v217 offset:4096
    ds_read_b64_tr_b16 v[118:119], v217 offset:5120
    ds_read_b64_tr_b16 v[120:121], v218 offset:4096
    ds_read_b64_tr_b16 v[122:123], v218 offset:5120
    ds_read_b64_tr_b16 v[124:125], v219 offset:4096
    ds_read_b64_tr_b16 v[126:127], v219 offset:5120
    ds_read_b64_tr_b16 v[128:129], v216 offset:8192
    ds_read_b64_tr_b16 v[130:131], v216 offset:9216
    ds_read_b64_tr_b16 v[132:133], v217 offset:8192
    ds_read_b64_tr_b16 v[134:135], v217 offset:9216
    ds_read_b64_tr_b16 v[136:137], v218 offset:8192
    ds_read_b64_tr_b16 v[138:139], v218 offset:9216
    ds_read_b64_tr_b16 v[140:141], v219 offset:8192
    ds_read_b64_tr_b16 v[142:143], v219 offset:9216
    ds_read_b64_tr_b16 v[144:145], v216 offset:12288
    ds_read_b64_tr_b16 v[146:147], v216 offset:13312
    ds_read_b64_tr_b16 v[148:149], v217 offset:12288
    ds_read_b64_tr_b16 v[150:151], v217 offset:13312
    ds_read_b64_tr_b16 v[152:153], v218 offset:12288
    ds_read_b64_tr_b16 v[154:155], v218 offset:13312
    ds_read_b64_tr_b16 v[156:157], v219 offset:12288
    ds_read_b64_tr_b16 v[158:159], v219 offset:13312
    ds_read_b64_tr_b16 v[160:161], v220 offset:0
    ds_read_b64_tr_b16 v[162:163], v220 offset:1024
    ds_read_b64_tr_b16 v[164:165], v221 offset:0
    ds_read_b64_tr_b16 v[166:167], v221 offset:1024
    ds_read_b64_tr_b16 v[168:169], v222 offset:0
    ds_read_b64_tr_b16 v[170:171], v222 offset:1024
    ds_read_b64_tr_b16 v[172:173], v223 offset:0
    ds_read_b64_tr_b16 v[174:175], v223 offset:1024
    ds_read_b64_tr_b16 v[176:177], v220 offset:4096
    ds_read_b64_tr_b16 v[178:179], v220 offset:5120
    ds_read_b64_tr_b16 v[180:181], v221 offset:4096
    ds_read_b64_tr_b16 v[182:183], v221 offset:5120
    ds_read_b64_tr_b16 v[184:185], v222 offset:4096
    ds_read_b64_tr_b16 v[186:187], v222 offset:5120
    ds_read_b64_tr_b16 v[188:189], v223 offset:4096
    ds_read_b64_tr_b16 v[190:191], v223 offset:5120
    ds_read_b64_tr_b16 v[192:193], v220 offset:8192
    ds_read_b64_tr_b16 v[194:195], v220 offset:9216
    ds_read_b64_tr_b16 v[196:197], v221 offset:8192
    ds_read_b64_tr_b16 v[198:199], v221 offset:9216
    ds_read_b64_tr_b16 v[200:201], v222 offset:8192
    ds_read_b64_tr_b16 v[202:203], v222 offset:9216
    ds_read_b64_tr_b16 v[204:205], v223 offset:8192
    ds_read_b64_tr_b16 v[206:207], v223 offset:9216
    v_mov_b32 v16, 0
    v_mov_b32 v17, 0
    v_mov_b32 v18, 0
    v_mov_b32 v19, 0
    v_mov_b32 v20, 0
    v_mov_b32 v21, 0
    v_mov_b32 v22, 0
    v_mov_b32 v23, 0
    v_mov_b32 v24, 0
    v_mov_b32 v25, 0
    v_mov_b32 v26, 0
    v_mov_b32 v27, 0
    v_mov_b32 v28, 0
    v_mov_b32 v29, 0
    v_mov_b32 v30, 0
    v_mov_b32 v31, 0
    s_mov_b32 s44, s28
    s_mov_b32 s45, s29
    s_mov_b32 s46, 4194304
    s_and_b32 s54, s56, 127
    s_lshl_b32 s54, s54, 15
    s_lshl_b32 s12, s4, 10
    s_add_u32 s54, s54, s12
    s_and_b32 s12, s5, 7
    s_lshl_b32 s12, s12, 7
    s_add_u32 s54, s54, s12
    s_add_u32 s55, s54, 16384
    s_lshl_b32 s11, 1, s5
    s_andn2_b32 s62, 0xffff, s11
    s_mov_b32 s63, 0
    s_cmp_lg_u32 s10, 1
    s_cbranch_scc1 T_go
    s_mov_b64 exec, s[62:63]
    s_mov_b32 s12, 0
T_t:
    s_waitcnt vmcnt(0)
    v_cmp_eq_u32 vcc, v234, v235
    s_add_u32 s12, s12, 1
    s_cbranch_vccz T_go
    buffer_load_dword v234, v236, s[48:51], s7 offen sc1
    s_cmp_lt_u32 s12, 0x40000
    s_cbranch_scc1 T_t
T_go:
    s_mov_b64 exec, -1
    s_barrier
    buffer_load_dwordx4 v[32:35], v242, s[48:51], s64 offen offset:0 sc1
    buffer_load_dwordx4 v[36:39], v242, s[48:51], s64 offen offset:2048 sc1
    s_add_u32 s12, s64, 4096
    buffer_load_dwordx4 v[40:43], v242, s[48:51], s12 offen offset:0 sc1
    buffer_load_dwordx4 v[44:47], v242, s[48:51], s12 offen offset:2048 sc1
    buffer_load_dwordx4 v[48:51], v242, s[48:51], s65 offen offset:0 sc1
    buffer_load_dwordx4 v[52:55], v242, s[48:51], s65 offen offset:2048 sc1
    s_add_u32 s12, s65, 4096
    buffer_load_dwordx4 v[56:59], v242, s[48:51], s12 offen offset:0 sc1
    buffer_load_dwordx4 v[60:63], v242, s[48:51], s12 offen offset:2048 sc1
    buffer_load_dwordx4 v[64:67], v242, s[48:51], s66 offen offset:0 sc1
    buffer_load_dwordx4 v[68:71], v242, s[48:51], s66 offen offset:2048 sc1
    s_add_u32 s12, s66, 4096
    buffer_load_dwordx4 v[72:75], v242, s[48:51], s12 offen offset:0 sc1
    buffer_load_dwordx4 v[76:79], v242, s[48:51], s12 offen offset:2048 sc1
    buffer_load_dwordx4 v[80:83], v242, s[48:51], s67 offen offset:0 sc1
    buffer_load_dwordx4 v[84:87], v242, s[48:51], s67 offen offset:2048 sc1
    s_add_u32 s12, s67, 4096
    buffer_load_dwordx4 v[88:91], v242, s[48:51], s12 offen offset:0 sc1
    buffer_load_dwordx4 v[92:95], v242, s[48:51], s12 offen offset:2048 sc1
    s_waitcnt vmcnt(15) lgkmcnt(15)
    v_mfma_f32_16x16x32_bf16 v[16:19], v[96:99], v[32:35], v[16:19]
    ds_read_b64_tr_b16 v[96:97], v220 offset:12288
    ds_read_b64_tr_b16 v[98:99], v220 offset:13312
    v_mfma_f32_16x16x32_bf16 v[20:23], v[100:103], v[32:35], v[20:23]
    ds_read_b64_tr_b16 v[100:101], v221 offset:12288
    ds_read_b64_tr_b16 v[102:103], v221 offset:13312
    v_mfma_f32_16x16x32_bf16 v[24:27], v[104:107], v[32:35], v[24:27]
    ds_read_b64_tr_b16 v[104:105], v222 offset:12288
    ds_read_b64_tr_b16 v[106:107], v222 offset:13312
    v_mfma_f32_16x16x32_bf16 v[28:31], v[108:111], v[32:35], v[28:31]
    ds_read_b64_tr_b16 v[108:109], v223 offset:12288
    ds_read_b64_tr_b16 v[110:111], v223 offset:13312
    s_waitcnt vmcnt(14)
    v_mfma_f32_16x16x32_bf16 v[16:19], v[112:115], v[36:39], v[16:19]
    ds_read_b64_tr_b16 v[112:113], v224 offset:0
    ds_read_b64_tr_b16 v[114:115], v224 offset:1024
    v_mfma_f32_16x16x32_bf16 v[20:23], v[116:119], v[36:39], v[20:23]
    ds_read_b64_tr_b16 v[116:117], v225 offset:0
    ds_read_b64_tr_b16 v[118:119], v225 offset:1024
    v_mfma_f32_16x16x32_bf16 v[24:27], v[120:123], v[36:39], v[24:27]
    ds_read_b64_tr_b16 v[120:121], v226 offset:0
    ds_read_b64_tr_b16 v[122:123], v226 offset:1024
    v_mfma_f32_16x16x32_bf16 v[28:31], v[124:127], v[36:39], v[28:31]
    ds_read_b64_tr_b16 v[124:125], v227 offset:0
    ds_read_b64_tr_b16 v[126:127], v227 offset:1024
    s_waitcnt vmcnt(13)
    v_mfma_f32_16x16x32_bf16 v[16:19], v[128:131], v[40:43], v[16:19]
    ds_read_b64_tr_b16 v[128:129], v224 offset:4096
    ds_read_b64_tr_b16 v[130:131], v224 offset:5120
    v_mfma_f32_16x16x32_bf16 v[20:23], v[132:135], v[40:43], v[20:23]
    ds_read_b64_tr_b16 v[132:133], v225 offset:4096
    ds_read_b64_tr_b16 v[134:135], v225 offset:5120
    v_mfma_f32_16x16x32_bf16 v[24:27], v[136:139], v[40:43], v[24:27]
    ds_read_b64_tr_b16 v[136:137], v226 offset:4096
    ds_read_b64_tr_b16 v[138:139], v226 offset:5120
    v_mfma_f32_16x16x32_bf16 v[28:31], v[140:143], v[40:43], v[28:31]
    ds_read_b64_tr_b16 v[140:141], v227 offset:4096
    ds_read_b64_tr_b16 v[142:143], v227 offset:5120
    s_waitcnt vmcnt(12)
    v_mfma_f32_16x16x32_bf16 v[16:19], v[144:147], v[44:47], v[16:19]
    ds_read_b64_tr_b16 v[144:145], v224 offset:8192
    ds_read_b64_tr_b16 v[146:147], v224 offset:9216
    v_mfma_f32_16x16x32_bf16 v[20:23], v[148:151], v[44:47], v[20:23]
    ds_read_b64_tr_b16 v[148:149], v225 offset:8192
    ds_read_b64_tr_b16 v[150:151], v225 offset:9216
    v_mfma_f32_16x16x32_bf16 v[24:27], v[152:155], v[44:47], v[24:27]
    ds_read_b64_tr_b16 v[152:153], v226 offset:8192
    ds_read_b64_tr_b16 v[154:155], v226 offset:9216
    v_mfma_f32_16x16x32_bf16 v[28:31], v[156:159], v[44:47], v[28:31]
    ds_read_b64_tr_b16 v[156:157], v227 offset:8192
    ds_read_b64_tr_b16 v[158:159], v227 offset:9216
    s_waitcnt vmcnt(11)
    v_mfma_f32_16x16x32_bf16 v[16:19], v[160:163], v[48:51], v[16:19]
    ds_read_b64_tr_b16 v[160:161], v224 offset:12288
    ds_read_b64_tr_b16 v[162:163], v224 offset:13312
    v_mfma_f32_16x16x32_bf16 v[20:23], v[164:167], v[48:51], v[20:23]
    ds_read_b64_tr_b16 v[164:165], v225 offset:12288
    ds_read_b64_tr_b16 v[166:167], v225 offset:13312
    v_mfma_f32_16x16x32_bf16 v[24:27], v[168:171], v[48:51], v[24:27]
    ds_read_b64_tr_b16 v[168:169], v226 offset:12288
    ds_read_b64_tr_b16 v[170:171], v226 offset:13312
    v_mfma_f32_16x16x32_bf16 v[28:31], v[172:175], v[48:51], v[28:31]
    ds_read_b64_tr_b16 v[172:173], v227 offset:12288
    ds_read_b64_tr_b16 v[174:175], v227 offset:13312
    s_waitcnt vmcnt(10) lgkmcnt(15)
    v_mfma_f32_16x16x32_bf16 v[16:19], v[176:179], v[52:55], v[16:19]
    ds_read_b64_tr_b16 v[176:177], v228 offset:0
    ds_read_b64_tr_b16 v[178:179], v228 offset:1024
    v_mfma_f32_16x16x32_bf16 v[20:23], v[180:183], v[52:55], v[20:23]
    ds_read_b64_tr_b16 v[180:181], v229 offset:0
    ds_read_b64_tr_b16 v[182:183], v229 offset:1024
    v_mfma_f32_16x16x32_bf16 v[24:27], v[184:187], v[52:55], v[24:27]
    ds_read_b64_tr_b16 v[184:185], v231 offset:0
    ds_read_b64_tr_b16 v[186:187], v231 offset:1024
    v_mfma_f32_16x16x32_bf16 v[28:31], v[188:191], v[52:55], v[28:31]
    ds_read_b64_tr_b16 v[188:189], v247 offset:0
    ds_read_b64_tr_b16 v[190:191], v247 offset:1024
    s_waitcnt vmcnt(9)
    v_mfma_f32_16x16x32_bf16 v[16:19], v[192:195], v[56:59], v[16:19]
    ds_read_b64_tr_b16 v[192:193], v228 offset:4096
    ds_read_b64_tr_b16 v[194:195], v228 offset:5120
    v_mfma_f32_16x16x32_bf16 v[20:23], v[196:199], v[56:59], v[20:23]
    ds_read_b64_tr_b16 v[196:197], v229 offset:4096
    ds_read_b64_tr_b16 v[198:199], v229 offset:5120
    v_mfma_f32_16x16x32_bf16 v[24:27], v[200:203], v[56:59], v[24:27]
    ds_read_b64_tr_b16 v[200:201], v231 offset:4096
    ds_read_b64_tr_b16 v[202:203], v231 offset:5120
    v_mfma_f32_16x16x32_bf16 v[28:31], v[204:207], v[56:59], v[28:31]
    ds_read_b64_tr_b16 v[204:205], v247 offset:4096
    ds_read_b64_tr_b16 v[206:207], v247 offset:5120
    s_waitcnt vmcnt(8)
    v_mfma_f32_16x16x32_bf16 v[16:19], v[96:99], v[60:63], v[16:19]
    ds_read_b64_tr_b16 v[96:97], v228 offset:8192
    ds_read_b64_tr_b16 v[98:99], v228 offset:9216
    v_mfma_f32_16x16x32_bf16 v[20:23], v[100:103], v[60:63], v[20:23]
    ds_read_b64_tr_b16 v[100:101], v229 offset:8192
    ds_read_b64_tr_b16 v[102:103], v229 offset:9216
    v_mfma_f32_16x16x32_bf16 v[24:27], v[104:107], v[60:63], v[24:27]
    ds_read_b64_tr_b16 v[104:105], v231 offset:8192
    ds_read_b64_tr_b16 v[106:107], v231 offset:9216
    v_mfma_f32_16x16x32_bf16 v[28:31], v[108:111], v[60:63], v[28:31]
    ds_read_b64_tr_b16 v[108:109], v247 offset:8192
    ds_read_b64_tr_b16 v[110:111], v247 offset:9216
    s_waitcnt vmcnt(7)
    v_mfma_f32_16x16x32_bf16 v[16:19], v[112:115], v[64:67], v[16:19]
    ds_read_b64_tr_b16 v[112:113], v228 offset:12288
    ds_read_b64_tr_b16 v[114:115], v228 offset:13312
    v_mfma_f32_16x16x32_bf16 v[20:23], v[116:119], v[64:67], v[20:23]
    ds_read_b64_tr_b16 v[116:117], v229 offset:12288
    ds_read_b64_tr_b16 v[118:119], v229 offset:13312
    v_mfma_f32_16x16x32_bf16 v[24:27], v[120:123], v[64:67], v[24:27]
    ds_read_b64_tr_b16 v[120:121], v231 offset:12288
    ds_read_b64_tr_b16 v[122:123], v231 offset:13312
    v_mfma_f32_16x16x32_bf16 v[28:31], v[124:127], v[64:67], v[28:31]
    ds_read_b64_tr_b16 v[124:125], v247 offset:12288
    ds_read_b64_tr_b16 v[126:127], v247 offset:13312
    s_waitcnt vmcnt(6)
    v_mfma_f32_16x16x32_bf16 v[16:19], v[128:131], v[68:71], v[16:19]
    v_mfma_f32_16x16x32_bf16 v[20:23], v[132:135], v[68:71], v[20:23]
    v_mfma_f32_16x16x32_bf16 v[24:27], v[136:139], v[68:71], v[24:27]
    v_mfma_f32_16x16x32_bf16 v[28:31], v[140:143], v[68:71], v[28:31]
    s_waitcnt vmcnt(5) lgkmcnt(15)
    v_mfma_f32_16x16x32_bf16 v[16:19], v[144:147], v[72:75], v[16:19]
    v_mfma_f32_16x16x32_bf16 v[20:23], v[148:151], v[72:75], v[20:23]
    v_mfma_f32_16x16x32_bf16 v[24:27], v[152:155], v[72:75], v[24:27]
    v_mfma_f32_16x16x32_bf16 v[28:31], v[156:159], v[72:75], v[28:31]
    s_waitcnt vmcnt(4)
    v_mfma_f32_16x16x32_bf16 v[16:19], v[160:163], v[76:79], v[16:19]
    v_mfma_f32_16x16x32_bf16 v[20:23], v[164:167], v[76:79], v[20:23]
    v_mfma_f32_16x16x32_bf16 v[24:27], v[168:171], v[76:79], v[24:27]
    v_mfma_f32_16x16x32_bf16 v[28:31], v[172:175], v[76:79], v[28:31]
    s_waitcnt vmcnt(3)
    v_mfma_f32_16x16x32_bf16 v[16:19], v[176:179], v[80:83], v[16:19]
    v_mfma_f32_16x16x32_bf16 v[20:23], v[180:183], v[80:83], v[20:23]
    v_mfma_f32_16x16x32_bf16 v[24:27], v[184:187], v[80:83], v[24:27]
    v_mfma_f32_16x16x32_bf16 v[28:31], v[188:191], v[80:83], v[28:31]
    s_waitcnt vmcnt(2)
    v_mfma_f32_16x16x32_bf16 v[16:19], v[192:195], v[84:87], v[16:19]
    v_mfma_f32_16x16x32_bf16 v[20:23], v[196:199], v[84:87], v[20:23]
    v_mfma_f32_16x16x32_bf16 v[24:27], v[200:203], v[84:87], v[24:27]
    v_mfma_f32_16x16x32_bf16 v[28:31], v[204:207], v[84:87], v[28:31]
    s_waitcnt vmcnt(1) lgkmcnt(14)
    v_mfma_f32_16x16x32_bf16 v[16:19], v[96:99], v[88:91], v[16:19]
    s_waitcnt lgkmcnt(12)
    v_mfma_f32_16x16x32_bf16 v[20:23], v[100:103], v[88:91], v[20:23]
    s_waitcnt lgkmcnt(10)
    v_mfma_f32_16x16x32_bf16 v[24:27], v[104:107], v[88:91], v[24:27]
    s_waitcnt lgkmcnt(8)
    v_mfma_f32_16x16x32_bf16 v[28:31], v[108:111], v[88:91], v[28:31]
    s_waitcnt vmcnt(0) lgkmcnt(6)
    v_mfma_f32_16x16x32_bf16 v[16:19], v[112:115], v[92:95], v[16:19]
    s_waitcnt lgkmcnt(4)
    v_mfma_f32_16x16x32_bf16 v[20:23], v[116:119], v[92:95], v[20:23]
    s_waitcnt lgkmcnt(2)
    v_mfma_f32_16x16x32_bf16 v[24:27], v[120:123], v[92:95], v[24:27]
    s_waitcnt lgkmcnt(0)
    v_mfma_f32_16x16x32_bf16 v[28:31], v[124:127], v[92:95], v[28:31]
    s_nop 7
    v_cmp_u_f32 vcc, v28, v28
    s_mov_b32 s69, 0
    s_cbranch_vccnz T_rare
T_out:
    v_cvt_pk_bf16_f32 v40, v16, v17
    v_cvt_pk_bf16_f32 v41, v18, v19
    ds_write_b64 v243, v[40:41] offset:0
    v_cvt_pk_bf16_f32 v42, v20, v21
    v_cvt_pk_bf16_f32 v43, v22, v23
    ds_write_b64 v243, v[42:43] offset:32
    v_cvt_pk_bf16_f32 v44, v24, v25
    v_cvt_pk_bf16_f32 v45, v26, v27
    ds_write_b64 v243, v[44:45] offset:64
    v_cvt_pk_bf16_f32 v46, v28, v29
    v_cvt_pk_bf16_f32 v47, v30, v31
    ds_write_b64 v243, v[46:47] offset:96
    ds_read_b128 v[48:51], v244
    ds_read_b128 v[52:55], v244 offset:1152
    s_waitcnt lgkmcnt(1)
    buffer_store_dwordx4 v[48:51], v245, s[44:47], s54 offen sc1
    s_waitcnt lgkmcnt(0)
    buffer_store_dwordx4 v[52:55], v245, s[44:47], s55 offen sc1
F_end:
    s_endpgm
F_pa_poll:
    s_mov_b32 s12, 0
F_pa_t:
    buffer_load_dword v234, v233, s[48:51], s57 offen sc1
    s_add_u32 s12, s12, 1
    s_and_b32 s11, s12, 7
    s_cbranch_scc1 F_pa_nd
    v_and_b32 v3, 7, v2
    buffer_load_ubyte v1, v3, s[36:39], s59 offen sc1
    s_waitcnt vmcnt(0)
    v_cmp_ne_u32 vcc, 0, v1
    s_nop 3
    s_or_b32 s68, s68, vcc_lo
F_pa_nd:
    s_waitcnt vmcnt(0)
    v_cmp_ne_u32 vcc, v234, v232
    s_nop 3
    s_or_b32 s68, s68, vcc_lo
    s_bitcmp1_b32 s68, s67
    s_cbranch_scc1 F_pa_ok
    s_cmp_lt_u32 s12, 0x40000
    s_cbranch_scc1 F_pa_t
    s_branch F_pa_ok
F_wait_first:
    ds_read_b32 v222, v220
    s_waitcnt lgkmcnt(0)
    v_cmp_gt_u32 vcc, v221, v222
    s_nop 0
    s_cbranch_vccnz F_wait_first
    s_branch F_go_first
F_pb_poll:
    s_mov_b32 s12, 0
F_pb_t:
    buffer_load_dword v234, v233, s[48:51], s57 offen sc1
    s_add_u32 s12, s12, 1
    s_and_b32 s11, s12, 7
    s_cbranch_scc1 F_pb_nd
    v_and_b32 v3, 7, v2
    buffer_load_ubyte v1, v3, s[36:39], s59 offen sc1
    s_waitcnt vmcnt(0)
    v_cmp_ne_u32 vcc, 0, v1
    s_nop 3
    s_or_b32 s68, s68, vcc_lo
F_pb_nd:
    s_waitcnt vmcnt(0)
    v_cmp_ne_u32 vcc, v234, v232
    s_nop 3
    s_or_b32 s68, s68, vcc_lo
    s_bitcmp1_b32 s68, s67
    s_cbranch_scc1 F_pb_ok
    s_cmp_lt_u32 s12, 0x40000
    s_cbranch_scc1 F_pb_t
    s_branch F_pb_ok
F_wait_mid:
    ds_read_b32 v222, v220
    s_waitcnt lgkmcnt(0)
    v_cmp_gt_u32 vcc, v221, v222
    s_nop 0
    s_cbranch_vccnz F_wait_mid
    s_branch F_go_mid
F_wait_last:
    ds_read_b32 v222, v220
    s_waitcnt lgkmcnt(0)
    v_cmp_gt_u32 vcc, v221, v222
    s_nop 0
    s_cbranch_vccnz F_wait_last
    s_branch F_go_last
F_special:
    s_cmp_eq_u32 s14, 1
    s_cbranch_scc0 F_sp6
    buffer_store_dwordx4 v[212:215], v4, s[48:51], s52 offen sc1
    buffer_store_dwordx4 v[212:215], v4, s[48:51], s53 offen sc1
    s_cmp_lg_u32 s10, 0
    s_cbranch_scc1 F_spret
    s_lshl_b32 s11, 1, s6
    v_mov_b32 v3, 1
    s_mov_b32 exec_hi, 0
    s_mov_b32 exec_lo, s11
    buffer_store_byte v3, v2, s[36:39], s59 offen sc1
    s_mov_b64 exec, -1
    s_branch F_spret
F_sp6:
    s_lshl_b32 s66, s4, 7
    s_add_u32 s66, s66, s6
    buffer_load_ubyte v240, v239, s[36:39], s66 offen sc1
    s_branch F_spret
F_notstarted:
    s_mov_b32 s12, 0
F_ns1:
    buffer_load_ubyte v240, v239, s[36:39], s66 offen sc1
    s_add_u32 s12, s12, 1
    s_waitcnt vmcnt(0)
    v_cmp_eq_u32 vcc, 0, v240
    s_cmp_lt_u32 s12, 0x40000
    s_cbranch_vccz F_started
    s_cbranch_scc1 F_ns1
    s_branch F_started
T_rare:
    s_mov_b32 s69, 0
    ds_read_b64_tr_b16 v[96:97], v216 offset:0
    ds_read_b64_tr_b16 v[98:99], v216 offset:1024
    ds_read_b64_tr_b16 v[100:101], v217 offset:0
    ds_read_b64_tr_b16 v[102:103], v217 offset:1024
    ds_read_b64_tr_b16 v[104:105], v218 offset:0
    ds_read_b64_tr_b16 v[106:107], v218 offset:1024
    ds_read_b64_tr_b16 v[108:109], v219 offset:0
    ds_read_b64_tr_b16 v[110:111], v219 offset:1024
    ds_read_b64_tr_b16 v[112:113], v216 offset:4096
    ds_read_b64_tr_b16 v[114:115], v216 offset:5120
    ds_read_b64_tr_b16 v[116:117], v217 offset:4096
    ds_read_b64_tr_b16 v[118:119], v217 offset:5120
    ds_read_b64_tr_b16 v[120:121], v218 offset:4096
    ds_read_b64_tr_b16 v[122:123], v218 offset:5120
    ds_read_b64_tr_b16 v[124:125], v219 offset:4096
    ds_read_b64_tr_b16 v[126:127], v219 offset:5120
    ds_read_b64_tr_b16 v[128:129], v216 offset:8192
    ds_read_b64_tr_b16 v[130:131], v216 offset:9216
    ds_read_b64_tr_b16 v[132:133], v217 offset:8192
    ds_read_b64_tr_b16 v[134:135], v217 offset:9216
    ds_read_b64_tr_b16 v[136:137], v218 offset:8192
    ds_read_b64_tr_b16 v[138:139], v218 offset:9216
    ds_read_b64_tr_b16 v[140:141], v219 offset:8192
    ds_read_b64_tr_b16 v[142:143], v219 offset:9216
    ds_read_b64_tr_b16 v[144:145], v216 offset:12288
    ds_read_b64_tr_b16 v[146:147], v216 offset:13312
    ds_read_b64_tr_b16 v[148:149], v217 offset:12288
    ds_read_b64_tr_b16 v[150:151], v217 offset:13312
    ds_read_b64_tr_b16 v[152:153], v218 offset:12288
    ds_read_b64_tr_b16 v[154:155], v218 offset:13312
    ds_read_b64_tr_b16 v[156:157], v219 offset:12288
    ds_read_b64_tr_b16 v[158:159], v219 offset:13312
    ds_read_b64_tr_b16 v[160:161], v220 offset:0
    ds_read_b64_tr_b16 v[162:163], v220 offset:1024
    ds_read_b64_tr_b16 v[164:165], v221 offset:0
    ds_read_b64_tr_b16 v[166:167], v221 offset:1024
    ds_read_b64_tr_b16 v[168:169], v222 offset:0
    ds_read_b64_tr_b16 v[170:171], v222 offset:1024
    ds_read_b64_tr_b16 v[172:173], v223 offset:0
    ds_read_b64_tr_b16 v[174:175], v223 offset:1024
    ds_read_b64_tr_b16 v[176:177], v220 offset:4096
    ds_read_b64_tr_b16 v[178:179], v220 offset:5120
    ds_read_b64_tr_b16 v[180:181], v221 offset:4096
    ds_read_b64_tr_b16 v[182:183], v221 offset:5120
    ds_read_b64_tr_b16 v[184:185], v222 offset:4096
    ds_read_b64_tr_b16 v[186:187], v222 offset:5120
    ds_read_b64_tr_b16 v[188:189], v223 offset:4096
    ds_read_b64_tr_b16 v[190:191], v223 offset:5120
    ds_read_b64_tr_b16 v[192:193], v220 offset:8192
    ds_read_b64_tr_b16 v[194:195], v220 offset:9216
    ds_read_b64_tr_b16 v[196:197], v221 offset:8192
    ds_read_b64_tr_b16 v[198:199], v221 offset:9216
    ds_read_b64_tr_b16 v[200:201], v222 offset:8192
    ds_read_b64_tr_b16 v[202:203], v222 offset:9216
    ds_read_b64_tr_b16 v[204:205], v223 offset:8192
    ds_read_b64_tr_b16 v[206:207], v223 offset:9216
    v_mov_b32 v16, 0
    v_mov_b32 v17, 0
    v_mov_b32 v18, 0
    v_mov_b32 v19, 0
    v_mov_b32 v20, 0
    v_mov_b32 v21, 0
    v_mov_b32 v22, 0
    v_mov_b32 v23, 0
    v_mov_b32 v24, 0
    v_mov_b32 v25, 0
    v_mov_b32 v26, 0
    v_mov_b32 v27, 0
    v_mov_b32 v28, 0
    v_mov_b32 v29, 0
    v_mov_b32 v30, 0
    v_mov_b32 v31, 0
T_r1:
    buffer_load_dwordx4 v[32:35], v242, s[48:51], s64 offen offset:0 sc1
    buffer_load_dwordx4 v[36:39], v242, s[48:51], s64 offen offset:2048 sc1
    s_add_u32 s12, s64, 4096
    buffer_load_dwordx4 v[40:43], v242, s[48:51], s12 offen offset:0 sc1
    buffer_load_dwordx4 v[44:47], v242, s[48:51], s12 offen offset:2048 sc1
    buffer_load_dwordx4 v[48:51], v242, s[48:51], s65 offen offset:0 sc1
    buffer_load_dwordx4 v[52:55], v242, s[48:51], s65 offen offset:2048 sc1
    s_add_u32 s12, s65, 4096
    buffer_load_dwordx4 v[56:59], v242, s[48:51], s12 offen offset:0 sc1
    buffer_load_dwordx4 v[60:63], v242, s[48:51], s12 offen offset:2048 sc1
    buffer_load_dwordx4 v[64:67], v242, s[48:51], s66 offen offset:0 sc1
    buffer_load_dwordx4 v[68:71], v242, s[48:51], s66 offen offset:2048 sc1
    s_add_u32 s12, s66, 4096
    buffer_load_dwordx4 v[72:75], v242, s[48:51], s12 offen offset:0 sc1
    buffer_load_dwordx4 v[76:79], v242, s[48:51], s12 offen offset:2048 sc1
    buffer_load_dwordx4 v[80:83], v242, s[48:51], s67 offen offset:0 sc1
    buffer_load_dwordx4 v[84:87], v242, s[48:51], s67 offen offset:2048 sc1
    s_add_u32 s12, s67, 4096
    buffer_load_dwordx4 v[88:91], v242, s[48:51], s12 offen offset:0 sc1
    buffer_load_dwordx4 v[92:95], v242, s[48:51], s12 offen offset:2048 sc1
    s_add_u32 s69, s69, 1
    s_waitcnt vmcnt(0)
    v_max_u32 v1, v32, v33
    v_max3_u32 v1, v1, v34, v35
    v_max3_u32 v1, v1, v36, v37
    v_max3_u32 v1, v1, v38, v39
    v_max3_u32 v1, v1, v40, v41
    v_max3_u32 v1, v1, v42, v43
    v_max3_u32 v1, v1, v44, v45
    v_max3_u32 v1, v1, v46, v47
    v_max3_u32 v1, v1, v48, v49
    v_max3_u32 v1, v1, v50, v51
    v_max3_u32 v1, v1, v52, v53
    v_max3_u32 v1, v1, v54, v55
    v_max3_u32 v1, v1, v56, v57
    v_max3_u32 v1, v1, v58, v59
    v_max3_u32 v1, v1, v60, v61
    v_max3_u32 v1, v1, v62, v63
    v_max3_u32 v1, v1, v64, v65
    v_max3_u32 v1, v1, v66, v67
    v_max3_u32 v1, v1, v68, v69
    v_max3_u32 v1, v1, v70, v71
    v_max3_u32 v1, v1, v72, v73
    v_max3_u32 v1, v1, v74, v75
    v_max3_u32 v1, v1, v76, v77
    v_max3_u32 v1, v1, v78, v79
    v_max3_u32 v1, v1, v80, v81
    v_max3_u32 v1, v1, v82, v83
    v_max3_u32 v1, v1, v84, v85
    v_max3_u32 v1, v1, v86, v87
    v_max3_u32 v1, v1, v88, v89
    v_max3_u32 v1, v1, v90, v91
    v_max3_u32 v1, v1, v92, v93
    v_max3_u32 v1, v1, v94, v95
    v_cmp_eq_u32 vcc, -1, v1
    s_cmp_lt_u32 s69, 0x4000
    s_cbranch_vccz T_r2
    s_cbranch_scc1 T_r1
T_r2:
    s_waitcnt lgkmcnt(15)
    v_mfma_f32_16x16x32_bf16 v[16:19], v[96:99], v[32:35], v[16:19]
    ds_read_b64_tr_b16 v[96:97], v220 offset:12288
    ds_read_b64_tr_b16 v[98:99], v220 offset:13312
    v_mfma_f32_16x16x32_bf16 v[20:23], v[100:103], v[32:35], v[20:23]
    ds_read_b64_tr_b16 v[100:101], v221 offset:12288
    ds_read_b64_tr_b16 v[102:103], v221 offset:13312
    v_mfma_f32_16x16x32_bf16 v[24:27], v[104:107], v[32:35], v[24:27]
    ds_read_b64_tr_b16 v[104:105], v222 offset:12288
    ds_read_b64_tr_b16 v[106:107], v222 offset:13312
    v_mfma_f32_16x16x32_bf16 v[28:31], v[108:111], v[32:35], v[28:31]
    ds_read_b64_tr_b16 v[108:109], v223 offset:12288
    ds_read_b64_tr_b16 v[110:111], v223 offset:13312
    v_mfma_f32_16x16x32_bf16 v[16:19], v[112:115], v[36:39], v[16:19]
    ds_read_b64_tr_b16 v[112:113], v224 offset:0
    ds_read_b64_tr_b16 v[114:115], v224 offset:1024
    v_mfma_f32_16x16x32_bf16 v[20:23], v[116:119], v[36:39], v[20:23]
    ds_read_b64_tr_b16 v[116:117], v225 offset:0
    ds_read_b64_tr_b16 v[118:119], v225 offset:1024
    v_mfma_f32_16x16x32_bf16 v[24:27], v[120:123], v[36:39], v[24:27]
    ds_read_b64_tr_b16 v[120:121], v226 offset:0
    ds_read_b64_tr_b16 v[122:123], v226 offset:1024
    v_mfma_f32_16x16x32_bf16 v[28:31], v[124:127], v[36:39], v[28:31]
    ds_read_b64_tr_b16 v[124:125], v227 offset:0
    ds_read_b64_tr_b16 v[126:127], v227 offset:1024
    v_mfma_f32_16x16x32_bf16 v[16:19], v[128:131], v[40:43], v[16:19]
    ds_read_b64_tr_b16 v[128:129], v224 offset:4096
    ds_read_b64_tr_b16 v[130:131], v224 offset:5120
    v_mfma_f32_16x16x32_bf16 v[20:23], v[132:135], v[40:43], v[20:23]
    ds_read_b64_tr_b16 v[132:133], v225 offset:4096
    ds_read_b64_tr_b16 v[134:135], v225 offset:5120
    v_mfma_f32_16x16x32_bf16 v[24:27], v[136:139], v[40:43], v[24:27]
    ds_read_b64_tr_b16 v[136:137], v226 offset:4096
    ds_read_b64_tr_b16 v[138:139], v226 offset:5120
    v_mfma_f32_16x16x32_bf16 v[28:31], v[140:143], v[40:43], v[28:31]
    ds_read_b64_tr_b16 v[140:141], v227 offset:4096
    ds_read_b64_tr_b16 v[142:143], v227 offset:5120
    v_mfma_f32_16x16x32_bf16 v[16:19], v[144:147], v[44:47], v[16:19]
    ds_read_b64_tr_b16 v[144:145], v224 offset:8192
    ds_read_b64_tr_b16 v[146:147], v224 offset:9216
    v_mfma_f32_16x16x32_bf16 v[20:23], v[148:151], v[44:47], v[20:23]
    ds_read_b64_tr_b16 v[148:149], v225 offset:8192
    ds_read_b64_tr_b16 v[150:151], v225 offset:9216
    v_mfma_f32_16x16x32_bf16 v[24:27], v[152:155], v[44:47], v[24:27]
    ds_read_b64_tr_b16 v[152:153], v226 offset:8192
    ds_read_b64_tr_b16 v[154:155], v226 offset:9216
    v_mfma_f32_16x16x32_bf16 v[28:31], v[156:159], v[44:47], v[28:31]
    ds_read_b64_tr_b16 v[156:157], v227 offset:8192
    ds_read_b64_tr_b16 v[158:159], v227 offset:9216
    v_mfma_f32_16x16x32_bf16 v[16:19], v[160:163], v[48:51], v[16:19]
    ds_read_b64_tr_b16 v[160:161], v224 offset:12288
    ds_read_b64_tr_b16 v[162:163], v224 offset:13312
    v_mfma_f32_16x16x32_bf16 v[20:23], v[164:167], v[48:51], v[20:23]
    ds_read_b64_tr_b16 v[164:165], v225 offset:12288
    ds_read_b64_tr_b16 v[166:167], v225 offset:13312
    v_mfma_f32_16x16x32_bf16 v[24:27], v[168:171], v[48:51], v[24:27]
    ds_read_b64_tr_b16 v[168:169], v226 offset:12288
    ds_read_b64_tr_b16 v[170:171], v226 offset:13312
    v_mfma_f32_16x16x32_bf16 v[28:31], v[172:175], v[48:51], v[28:31]
    ds_read_b64_tr_b16 v[172:173], v227 offset:12288
    ds_read_b64_tr_b16 v[174:175], v227 offset:13312
    s_waitcnt lgkmcnt(15)
    v_mfma_f32_16x16x32_bf16 v[16:19], v[176:179], v[52:55], v[16:19]
    ds_read_b64_tr_b16 v[176:177], v228 offset:0
    ds_read_b64_tr_b16 v[178:179], v228 offset:1024
    v_mfma_f32_16x16x32_bf16 v[20:23], v[180:183], v[52:55], v[20:23]
    ds_read_b64_tr_b16 v[180:181], v229 offset:0
    ds_read_b64_tr_b16 v[182:183], v229 offset:1024
    v_mfma_f32_16x16x32_bf16 v[24:27], v[184:187], v[52:55], v[24:27]
    ds_read_b64_tr_b16 v[184:185], v231 offset:0
    ds_read_b64_tr_b16 v[186:187], v231 offset:1024
    v_mfma_f32_16x16x32_bf16 v[28:31], v[188:191], v[52:55], v[28:31]
    ds_read_b64_tr_b16 v[188:189], v247 offset:0
    ds_read_b64_tr_b16 v[190:191], v247 offset:1024
    v_mfma_f32_16x16x32_bf16 v[16:19], v[192:195], v[56:59], v[16:19]
    ds_read_b64_tr_b16 v[192:193], v228 offset:4096
    ds_read_b64_tr_b16 v[194:195], v228 offset:5120
    v_mfma_f32_16x16x32_bf16 v[20:23], v[196:199], v[56:59], v[20:23]
    ds_read_b64_tr_b16 v[196:197], v229 offset:4096
    ds_read_b64_tr_b16 v[198:199], v229 offset:5120
    v_mfma_f32_16x16x32_bf16 v[24:27], v[200:203], v[56:59], v[24:27]
    ds_read_b64_tr_b16 v[200:201], v231 offset:4096
    ds_read_b64_tr_b16 v[202:203], v231 offset:5120
    v_mfma_f32_16x16x32_bf16 v[28:31], v[204:207], v[56:59], v[28:31]
    ds_read_b64_tr_b16 v[204:205], v247 offset:4096
    ds_read_b64_tr_b16 v[206:207], v247 offset:5120
    v_mfma_f32_16x16x32_bf16 v[16:19], v[96:99], v[60:63], v[16:19]
    ds_read_b64_tr_b16 v[96:97], v228 offset:8192
    ds_read_b64_tr_b16 v[98:99], v228 offset:9216
    v_mfma_f32_16x16x32_bf16 v[20:23], v[100:103], v[60:63], v[20:23]
    ds_read_b64_tr_b16 v[100:101], v229 offset:8192
    ds_read_b64_tr_b16 v[102:103], v229 offset:9216
    v_mfma_f32_16x16x32_bf16 v[24:27], v[104:107], v[60:63], v[24:27]
    ds_read_b64_tr_b16 v[104:105], v231 offset:8192
    ds_read_b64_tr_b16 v[106:107], v231 offset:9216
    v_mfma_f32_16x16x32_bf16 v[28:31], v[108:111], v[60:63], v[28:31]
    ds_read_b64_tr_b16 v[108:109], v247 offset:8192
    ds_read_b64_tr_b16 v[110:111], v247 offset:9216
    v_mfma_f32_16x16x32_bf16 v[16:19], v[112:115], v[64:67], v[16:19]
    ds_read_b64_tr_b16 v[112:113], v228 offset:12288
    ds_read_b64_tr_b16 v[114:115], v228 offset:13312
    v_mfma_f32_16x16x32_bf16 v[20:23], v[116:119], v[64:67], v[20:23]
    ds_read_b64_tr_b16 v[116:117], v229 offset:12288
    ds_read_b64_tr_b16 v[118:119], v229 offset:13312
    v_mfma_f32_16x16x32_bf16 v[24:27], v[120:123], v[64:67], v[24:27]
    ds_read_b64_tr_b16 v[120:121], v231 offset:12288
    ds_read_b64_tr_b16 v[122:123], v231 offset:13312
    v_mfma_f32_16x16x32_bf16 v[28:31], v[124:127], v[64:67], v[28:31]
    ds_read_b64_tr_b16 v[124:125], v247 offset:12288
    ds_read_b64_tr_b16 v[126:127], v247 offset:13312
    v_mfma_f32_16x16x32_bf16 v[16:19], v[128:131], v[68:71], v[16:19]
    v_mfma_f32_16x16x32_bf16 v[20:23], v[132:135], v[68:71], v[20:23]
    v_mfma_f32_16x16x32_bf16 v[24:27], v[136:139], v[68:71], v[24:27]
    v_mfma_f32_16x16x32_bf16 v[28:31], v[140:143], v[68:71], v[28:31]
    s_waitcnt lgkmcnt(15)
    v_mfma_f32_16x16x32_bf16 v[16:19], v[144:147], v[72:75], v[16:19]
    v_mfma_f32_16x16x32_bf16 v[20:23], v[148:151], v[72:75], v[20:23]
    v_mfma_f32_16x16x32_bf16 v[24:27], v[152:155], v[72:75], v[24:27]
    v_mfma_f32_16x16x32_bf16 v[28:31], v[156:159], v[72:75], v[28:31]
    v_mfma_f32_16x16x32_bf16 v[16:19], v[160:163], v[76:79], v[16:19]
    v_mfma_f32_16x16x32_bf16 v[20:23], v[164:167], v[76:79], v[20:23]
    v_mfma_f32_16x16x32_bf16 v[24:27], v[168:171], v[76:79], v[24:27]
    v_mfma_f32_16x16x32_bf16 v[28:31], v[172:175], v[76:79], v[28:31]
    v_mfma_f32_16x16x32_bf16 v[16:19], v[176:179], v[80:83], v[16:19]
    v_mfma_f32_16x16x32_bf16 v[20:23], v[180:183], v[80:83], v[20:23]
    v_mfma_f32_16x16x32_bf16 v[24:27], v[184:187], v[80:83], v[24:27]
    v_mfma_f32_16x16x32_bf16 v[28:31], v[188:191], v[80:83], v[28:31]
    v_mfma_f32_16x16x32_bf16 v[16:19], v[192:195], v[84:87], v[16:19]
    v_mfma_f32_16x16x32_bf16 v[20:23], v[196:199], v[84:87], v[20:23]
    v_mfma_f32_16x16x32_bf16 v[24:27], v[200:203], v[84:87], v[24:27]
    v_mfma_f32_16x16x32_bf16 v[28:31], v[204:207], v[84:87], v[28:31]
    s_waitcnt lgkmcnt(14)
    v_mfma_f32_16x16x32_bf16 v[16:19], v[96:99], v[88:91], v[16:19]
    s_waitcnt lgkmcnt(12)
    v_mfma_f32_16x16x32_bf16 v[20:23], v[100:103], v[88:91], v[20:23]
    s_waitcnt lgkmcnt(10)
    v_mfma_f32_16x16x32_bf16 v[24:27], v[104:107], v[88:91], v[24:27]
    s_waitcnt lgkmcnt(8)
    v_mfma_f32_16x16x32_bf16 v[28:31], v[108:111], v[88:91], v[28:31]
    s_waitcnt lgkmcnt(6)
    v_mfma_f32_16x16x32_bf16 v[16:19], v[112:115], v[92:95], v[16:19]
    s_waitcnt lgkmcnt(4)
    v_mfma_f32_16x16x32_bf16 v[20:23], v[116:119], v[92:95], v[20:23]
    s_waitcnt lgkmcnt(2)
    v_mfma_f32_16x16x32_bf16 v[24:27], v[120:123], v[92:95], v[24:27]
    s_waitcnt lgkmcnt(0)
    v_mfma_f32_16x16x32_bf16 v[28:31], v[124:127], v[92:95], v[28:31]
    s_nop 7
    s_branch T_out
F_slow:
    s_lshl_b32 s64, s10, 12
    s_sub_u32 s64, s13, s64
    s_add_u32 s64, s64, s8
    s_mov_b32 s14, 0
    v_mov_b32 v237, 0xff800000
    v_mov_b32 v238, 0xff800000
F_s1:
    s_lshl_b32 s65, s14, 12
    s_add_u32 s65, s65, s64
    buffer_load_dwordx4 v[24:27], v4, s[48:51], s65 offen sc1
    s_waitcnt vmcnt(0)
    v_mfma_f32_32x32x16_bf16 v[144:159], v[24:27], v[16:19], 0
    v_mfma_f32_32x32x16_bf16 v[160:175], v[24:27], v[20:23], 0
    s_nop 15
    v_max3_f32 v237, v237, v144, v145
    v_max3_f32 v237, v237, v146, v147
    v_max3_f32 v237, v237, v148, v149
    v_max3_f32 v237, v237, v150, v151
    v_max3_f32 v237, v237, v152, v153
    v_max3_f32 v237, v237, v154, v155
    v_max3_f32 v237, v237, v156, v157
    v_max3_f32 v237, v237, v158, v159
    v_max3_f32 v238, v238, v160, v161
    v_max3_f32 v238, v238, v162, v163
    v_max3_f32 v238, v238, v164, v165
    v_max3_f32 v238, v238, v166, v167
    v_max3_f32 v238, v238, v168, v169
    v_max3_f32 v238, v238, v170, v171
    v_max3_f32 v238, v238, v172, v173
    v_max3_f32 v238, v238, v174, v175
    s_add_u32 s14, s14, 1
    s_cmp_lt_u32 s14, 64
    s_cbranch_scc1 F_s1
    v_mov_b32 v1, v237
    v_mov_b32 v3, v238
    s_nop 1
    v_permlane32_swap_b32 v237, v1
    v_permlane32_swap_b32 v238, v3
    s_nop 1
    v_max_f32 v237, v237, v1
    v_max_f32 v238, v238, v3
    v_sub_f32 v64, 0, v237
    v_sub_f32 v65, 0, v237
    v_sub_f32 v66, 0, v237
    v_sub_f32 v67, 0, v237
    v_sub_f32 v68, 0, v237
    v_sub_f32 v69, 0, v237
    v_sub_f32 v70, 0, v237
    v_sub_f32 v71, 0, v237
    v_sub_f32 v72, 0, v237
    v_sub_f32 v73, 0, v237
    v_sub_f32 v74, 0, v237
    v_sub_f32 v75, 0, v237
    v_sub_f32 v76, 0, v237
    v_sub_f32 v77, 0, v237
    v_sub_f32 v78, 0, v237
    v_sub_f32 v79, 0, v237
    v_mov_b32 v176, 0
    v_mov_b32 v177, 0
    v_mov_b32 v178, 0
    v_mov_b32 v179, 0
    v_mov_b32 v180, 0
    v_mov_b32 v181, 0
    v_mov_b32 v182, 0
    v_mov_b32 v183, 0
    v_mov_b32 v184, 0
    v_mov_b32 v185, 0
    v_mov_b32 v186, 0
    v_mov_b32 v187, 0
    v_mov_b32 v188, 0
    v_mov_b32 v189, 0
    v_mov_b32 v190, 0
    v_mov_b32 v191, 0
    v_sub_f32 v80, 0, v238
    v_sub_f32 v81, 0, v238
    v_sub_f32 v82, 0, v238
    v_sub_f32 v83, 0, v238
    v_sub_f32 v84, 0, v238
    v_sub_f32 v85, 0, v238
    v_sub_f32 v86, 0, v238
    v_sub_f32 v87, 0, v238
    v_sub_f32 v88, 0, v238
    v_sub_f32 v89, 0, v238
    v_sub_f32 v90, 0, v238
    v_sub_f32 v91, 0, v238
    v_sub_f32 v92, 0, v238
    v_sub_f32 v93, 0, v238
    v_sub_f32 v94, 0, v238
    v_sub_f32 v95, 0, v238
    v_mov_b32 v192, 0
    v_mov_b32 v193, 0
    v_mov_b32 v194, 0
    v_mov_b32 v195, 0
    v_mov_b32 v196, 0
    v_mov_b32 v197, 0
    v_mov_b32 v198, 0
    v_mov_b32 v199, 0
    v_mov_b32 v200, 0
    v_mov_b32 v201, 0
    v_mov_b32 v202, 0
    v_mov_b32 v203, 0
    v_mov_b32 v204, 0
    v_mov_b32 v205, 0
    v_mov_b32 v206, 0
    v_mov_b32 v207, 0
    s_mov_b32 s14, 0
    s_mov_b32 s62, 0x0000ffff
    s_mov_b32 s63, 0x0000ffff
F_s2:
    s_lshl_b32 s65, s14, 12
    s_add_u32 s65, s65, s64
    buffer_load_dwordx4 v[24:27], v4, s[48:51], s65 offen sc1
    s_mov_b64 exec, s[62:63]
    buffer_load_dwordx4 v[32:35], v230, s[48:51], s65 offen offset:1024 sc1
    buffer_load_dwordx4 v[36:39], v230, s[48:51], s65 offen offset:1536 sc1
    s_mov_b64 exec, -1
    s_waitcnt vmcnt(0)
    v_mfma_f32_32x32x16_bf16 v[144:159], v[24:27], v[16:19], v[64:79]
    v_mfma_f32_32x32x16_bf16 v[160:175], v[24:27], v[20:23], v[80:95]
    s_nop 15
    v_exp_f32 v144, v144
    v_exp_f32 v145, v145
    v_exp_f32 v146, v146
    v_exp_f32 v147, v147
    v_exp_f32 v148, v148
    v_exp_f32 v149, v149
    v_exp_f32 v150, v150
    v_exp_f32 v151, v151
    v_exp_f32 v152, v152
    v_exp_f32 v153, v153
    v_exp_f32 v154, v154
    v_exp_f32 v155, v155
    v_exp_f32 v156, v156
    v_exp_f32 v157, v157
    v_exp_f32 v158, v158
    v_exp_f32 v159, v159
    v_exp_f32 v160, v160
    v_exp_f32 v161, v161
    v_exp_f32 v162, v162
    v_exp_f32 v163, v163
    v_exp_f32 v164, v164
    v_exp_f32 v165, v165
    v_exp_f32 v166, v166
    v_exp_f32 v167, v167
    v_exp_f32 v168, v168
    v_exp_f32 v169, v169
    v_exp_f32 v170, v170
    v_exp_f32 v171, v171
    v_exp_f32 v172, v172
    v_exp_f32 v173, v173
    v_exp_f32 v174, v174
    v_exp_f32 v175, v175
    s_nop 1
    v_smfmac_f32_32x32x32_bf16 v[176:191], v[32:35], v[144:151], v223
    v_smfmac_f32_32x32x32_bf16 v[176:191], v[36:39], v[152:159], v223
    v_smfmac_f32_32x32x32_bf16 v[192:207], v[32:35], v[160:167], v223
    v_smfmac_f32_32x32x32_bf16 v[192:207], v[36:39], v[168:175], v223
    s_nop 15
    s_add_u32 s14, s14, 1
    s_cmp_lt_u32 s14, 64
    s_cbranch_scc1 F_s2
    s_nop 7
    v_rcp_f32 v237, v184
    v_rcp_f32 v238, v200
    s_nop 1
    s_branch F_fin
.section .rodata,"a"
.p2align 6
.amdhsa_kernel concat_heads__softmax_full_mha__softmax_full_mha__prompt_kernel
  .amdhsa_next_free_vgpr 256
  .amdhsa_next_free_sgpr 102
  .amdhsa_accum_offset 256
  .amdhsa_group_segment_fixed_size 0
  .amdhsa_kernarg_size 72
  .amdhsa_user_sgpr_count 2
  .amdhsa_user_sgpr_kernarg_segment_ptr 1
  .amdhsa_system_sgpr_workgroup_id_x 1
.end_amdhsa_kernel
.text
```
